```python
import torch

def _softmax(x, axis=-1):
    return torch.softmax(x, dim=axis)
def _gelu(x):
    return torch.nn.functional.gelu(x, approximate="tanh")
def _silu(x):
    return torch.nn.functional.silu(x)
def _sigmoid(x):
    return torch.sigmoid(x)
def _layernorm(x, axis=-1, eps=1e-5):
    m = x.mean(dim=axis, keepdim=True)
    v = x.var(dim=axis, keepdim=True, unbiased=False)
    return (x - m) / torch.sqrt(v + eps)
def _scatter_add(tgt, idx, src, axis=0):
    return tgt.clone().index_add_(axis, idx, src)
def _segment_sum(src, seg, n):
    out = torch.zeros((n,) + src.shape[1:], dtype=src.dtype)
    return out.index_add_(0, seg, src)
def _pad(x, pw):
    flat = tuple(v for pair in reversed(pw) for v in pair)
    return torch.nn.functional.pad(x, flat)

kernel_name = 'sequential_preLN__gqa_block_cached__mixer_token_mlp__decode'

def setup_inputs():

    _w = (lambda a: (lambda t: t.to(torch.bfloat16) if t.is_floating_point() else t)(torch.as_tensor(a)))
    def _A_setup():
        B, Sq, D = 8, 1, 512
        Hq, Hkv, Sk, Dh = 32, 8, 8192, 128
        assert Hq % Hkv == 0, (Hq, Hkv)
        return {
            "x": _w((lambda *s: torch.randn(*s, dtype=torch.bfloat16) * 0.05)(B, Sq, D)),
            "k_cache": _w((lambda *s: torch.randn(*s, dtype=torch.bfloat16) * 1.6)(B, Hkv, Sk, Dh)),
            "v_cache": _w((lambda *s: torch.randn(*s, dtype=torch.bfloat16) * 0.8)(B, Hkv, Sk, Dh)),
            "wq": _w((lambda *s: torch.randn(*s, dtype=torch.bfloat16) * 1.6)(D, Hq * Dh) * (D ** -0.5)),
            "wo": _w((lambda *s: torch.randn(*s, dtype=torch.bfloat16) * 0.8)(Hq * Dh, D) * ((Hq * Dh) ** -0.5)),
        }
    _A_in = _A_setup()

    def _B_setup():
        B, S, D, F = 8, 1, 512, 1792
        return {
            "x": _w((lambda *s: torch.randn(*s, dtype=torch.bfloat16) * 0.05)(B, S, D)),
            "w1": _w((lambda *s: torch.randn(*s, dtype=torch.bfloat16) * 1.6)(S, F) * (S ** -0.5)),
            "b1": _w((lambda *s: torch.randn(*s, dtype=torch.bfloat16) * 1.6)(F) * 0.02),
            "w2": _w((lambda *s: torch.randn(*s, dtype=torch.bfloat16) * 1.6)(F, S) * (F ** -0.5)),
            "b2": _w((lambda *s: torch.randn(*s, dtype=torch.bfloat16) * 0.8)(S) * 0.02),
        }
    _B_in = _B_setup()

    return {
        "A_x": _A_in["x"],
        "A_k_cache": _A_in["k_cache"],
        "A_v_cache": _A_in["v_cache"],
        "A_wq": _A_in["wq"],
        "A_wo": _A_in["wo"],
        "B_x": _B_in["x"],
        "B_w1": _B_in["w1"],
        "B_b1": _B_in["b1"],
        "B_w2": _B_in["w2"],
        "B_b2": _B_in["b2"],
    }

def reference(A_x, A_k_cache, A_v_cache, A_wq, A_wo, B_x, B_w1, B_b1, B_w2, B_b2):
    def _A_ref(x, k_cache, v_cache, wq, wo):
        B, Sq, D = x.shape
        Hq, Dh = 32, 128
        Hkv = k_cache.shape[1]
        rep = Hq // Hkv
        q = (lambda x, *d: x.permute(*d))((x @ wq).reshape(B, Sq, Hq, Dh), 0, 2, 1, 3)
        k = (lambda x, n, axis: torch.repeat_interleave(x, n, dim=axis))(k_cache, rep, axis=1)
        v = (lambda x, n, axis: torch.repeat_interleave(x, n, dim=axis))(v_cache, rep, axis=1)
        scores = torch.einsum("bhqd,bhkd->bhqk", q, k) * (Dh ** -0.5)
        p = _softmax(scores, axis=-1)
        o = torch.einsum("bhqk,bhkd->bhqd", p, v)
        return (lambda x, *d: x.permute(*d))(o, 0, 2, 1, 3).reshape(B, Sq, Hq * Dh) @ wo

    def _B_ref(x, w1, b1, w2, b2):
        B, S, D = x.shape
        h = _layernorm(x, axis=-1)
        u = torch.einsum("bsd,sf->bdf", h, w1) + b1
        u = _gelu(u)
        y = torch.einsum("bdf,fs->bds", u, w2) + b2
        return (lambda x, *d: x.permute(*d))(y, 0, 2, 1)

    x = A_x
    h = x + _A_ref(_layernorm(x, axis=-1), A_k_cache, A_v_cache, A_wq, A_wo)
    h2 = h + _B_ref(_layernorm(h, axis=-1), B_w1, B_b1, B_w2, B_b2)
    return h2
```

```asm
; @launch grid=(256,1,1) block=(512,1,1) lds=163840
.amdgcn_target "amdgcn-amd-amdhsa--gfx950"
.text
.globl sequential_preLN__gqa_block_cached__mixer_token_mlp__decode_kernel
.p2align 8
.type sequential_preLN__gqa_block_cached__mixer_token_mlp__decode_kernel,@function
sequential_preLN__gqa_block_cached__mixer_token_mlp__decode_kernel:
    s_cmp_ge_u32 s2, 256
    s_cbranch_scc1 L_exit2
    s_load_dwordx8 s[4:11], s[0:1], 0
    s_load_dwordx2 s[12:13], s[0:1], 32
    s_load_dwordx8 s[16:23], s[0:1], 48
    s_load_dwordx4 s[24:27], s[0:1], 80
    s_load_dwordx2 s[28:29], s[0:1], 96
    s_memrealtime s[30:31]
    v_lshrrev_b32 v1, 6, v0
    v_and_b32 v2, 63, v0
    v_lshrrev_b32 v3, 4, v2
    v_readfirstlane_b32 s3, v1
    v_mov_b32 v4, 0
    v_mov_b32 v5, 0
    v_mov_b32 v6, 0
    v_mov_b32 v7, 0
    v_mov_b32 v8, 0
    v_mov_b32 v9, 0
    v_mov_b32 v10, 0
    v_mov_b32 v11, 0
    v_mov_b32 v12, 0
    v_mov_b32 v13, 0
    v_mov_b32 v14, 0
    v_mov_b32 v15, 0
    v_mov_b32 v16, 0
    v_mov_b32 v17, 0
    v_mov_b32 v18, 0
    v_mov_b32 v19, 0
    v_mov_b32 v20, 0
    v_mov_b32 v21, 0
    v_mov_b32 v22, 0
    v_mov_b32 v23, 0
    v_mov_b32 v24, 0
    v_mov_b32 v25, 0
    v_mov_b32 v26, 0
    v_mov_b32 v27, 0
    v_mov_b32 v28, 0
    v_mov_b32 v29, 0
    v_mov_b32 v30, 0
    v_mov_b32 v31, 0
    v_mov_b32 v32, 0
    v_mov_b32 v33, 0
    v_mov_b32 v34, 0
    v_mov_b32 v35, 0
    s_mov_b32 s88, 0
    s_mov_b32 s89, 0
    s_mov_b32 s74, 0
    s_mov_b32 s78, 0
    s_mov_b32 s79, 0
    v_and_b32 v22, 15, v2
    s_and_b32 s75, s2, 7
    s_lshr_b32 s73, s75, 1
    s_xor_b32 s76, s75, s73
    s_and_b32 s76, s76, 1
    s_lshr_b32 s72, s2, 3
    s_lshl_b32 s72, s72, 1
    s_add_u32 s72, s72, s76
    s_lshr_b32 s75, s2, 5
    s_lshl_b32 s75, s75, 3
    s_and_b32 s76, s2, 7
    s_add_u32 s75, s75, s76
    s_lshl_b32 s75, s75, 2
    s_lshr_b32 s76, s2, 3
    s_and_b32 s76, s76, 3
    s_add_u32 s88, s75, s76
    v_lshrrev_b32 v12, 1, v2
    v_lshlrev_b32 v12, 13, v12
    v_and_b32 v13, 1, v2
    v_lshl_add_u32 v12, v13, 4, v12
    s_sub_u32 s89, s3, 4
    s_lshl_b32 s82, s88, 5
    s_lshl_b32 s76, s89, 18
    s_add_u32 s82, s82, s76
    s_lshl_b32 s83, s89, 10
    s_add_u32 s83, s83, 139264
    s_lshl_b32 s77, s3, 10
    v_lshlrev_b32 v5, 4, v2
    s_waitcnt lgkmcnt(0)
    s_mov_b32 s44, s4
    s_mov_b32 s45, s5
    s_mov_b32 s46, 8192
    s_mov_b32 s47, 0x00020000
    s_mov_b32 s48, s10
    s_mov_b32 s49, s11
    s_mov_b32 s50, 4194304
    s_mov_b32 s51, 0x00020000
    buffer_load_dwordx4 v[8:11], v5, s[44:47], s77 offen
    s_cmp_lt_u32 s3, 4
    s_cbranch_scc1 L_nowq
    s_mov_b32 m0, s83
    s_nop 0
    buffer_load_dwordx4 v12, s[48:51], s82 offen lds
    s_add_u32 s83, s83, 4096
    s_add_u32 s82, s82, 1048576
    s_mov_b32 m0, s83
    s_nop 0
    buffer_load_dwordx4 v12, s[48:51], s82 offen lds
    s_add_u32 s83, s83, 4096
    s_add_u32 s82, s82, 1048576
    s_mov_b32 m0, s83
    s_nop 0
    buffer_load_dwordx4 v12, s[48:51], s82 offen lds
    s_add_u32 s83, s83, 4096
    s_add_u32 s82, s82, 1048576
    s_mov_b32 m0, s83
    s_nop 0
    buffer_load_dwordx4 v12, s[48:51], s82 offen lds
L_nowq:
    s_lshl_b32 s75, s72, 21
    s_add_u32 s32, s6, s75
    s_addc_u32 s33, s7, 0
    s_mov_b32 s34, 0x200000
    s_mov_b32 s35, 0x00020000
    s_add_u32 s36, s8, s75
    s_addc_u32 s37, s9, 0
    s_mov_b32 s38, 0x200000
    s_mov_b32 s39, 0x00020000
    s_mov_b32 s40, s28
    s_mov_b32 s41, s29
    s_mov_b32 s42, 1572864
    s_mov_b32 s43, 0x00020000
    s_mov_b32 s52, s16
    s_mov_b32 s53, s17
    s_mov_b32 s54, 3584
    s_mov_b32 s55, 0x00020000
    s_mov_b32 s56, s18
    s_mov_b32 s57, s19
    s_mov_b32 s58, 3584
    s_mov_b32 s59, 0x00020000
    s_mov_b32 s60, s20
    s_mov_b32 s61, s21
    s_mov_b32 s62, 3584
    s_mov_b32 s63, 0x00020000
    s_mov_b32 s64, s22
    s_mov_b32 s65, s23
    s_mov_b32 s66, 2
    s_mov_b32 s67, 0x00020000
    s_mov_b32 s68, s24
    s_mov_b32 s69, s25
    s_mov_b32 s70, 8192
    s_mov_b32 s71, 0x00020000
    s_mov_b32 s84, s12
    s_mov_b32 s85, s13
    s_mov_b32 s86, 4194304
    s_mov_b32 s87, 0x00020000
    s_mov_b32 s101, s3
    s_mov_b32 s98, 0
    s_mov_b32 s80, 0x3db504f3
    s_mov_b32 s81, 0x3fb8aa3b
    s_cmp_ge_u32 s3, 4
    s_cbranch_scc1 L_helper_h1
    s_cmp_lg_u32 s3, 3
    s_cbranch_scc1 L_h1_noclear
    v_mov_b32 v16, -1
    v_mov_b32 v17, -1
    v_mov_b32 v18, -1
    v_mov_b32 v19, -1
    v_lshlrev_b32 v12, 11, v3
    v_lshl_add_u32 v12, v22, 5, v12
    s_lshl_b32 s75, s72, 13
    s_lshl_b32 s76, s73, 9
    s_add_u32 s75, s75, s76
    s_add_u32 s75, s75, 65536
    buffer_store_dwordx4 v[16:19], v12, s[40:43], s75 offen sc1
    buffer_store_dwordx4 v[16:19], v12, s[40:43], s75 offen offset:16 sc1
    v_lshrrev_b32 v12, 3, v2
    v_lshlrev_b32 v12, 15, v12
    v_and_b32 v13, 7, v2
    v_lshl_add_u32 v12, v13, 4, v12
    s_lshr_b32 s75, s2, 4
    s_lshl_b32 s75, s75, 11
    s_and_b32 s76, s2, 7
    s_lshl_b32 s76, s76, 8
    s_add_u32 s75, s75, s76
    s_bfe_u32 s76, s2, 0x10003
    s_lshl_b32 s76, s76, 7
    s_add_u32 s75, s75, s76
    s_add_u32 s75, s75, 655360
    buffer_store_dwordx4 v[16:19], v12, s[40:43], s75 offen sc1
    v_lshlrev_b32 v12, 5, v2
    s_lshl_b32 s75, s72, 7
    s_lshl_b32 s76, s73, 3
    s_add_u32 s75, s75, s76
    s_add_u32 s75, s75, 589824
    s_mov_b64 exec, 15
    buffer_store_dwordx2 v[16:17], v12, s[40:43], s75 offen sc1
    s_mov_b64 exec, -1
    s_and_b32 s75, s2, 31
    s_cmp_ge_u32 s75, 8
    s_cbranch_scc1 L_h1_cleared
    s_lshl_b32 s75, s75, 3
    s_lshr_b32 s76, s2, 5
    s_add_u32 s75, s75, s76
    s_lshl_b32 s75, s75, 8
    s_add_u32 s75, s75, 983040
    v_mov_b32 v12, 0
    v_lshlrev_b32 v13, 6, v2
    s_mov_b64 exec, 15
    buffer_store_dword v12, v13, s[40:43], s75 offen sc1
    s_mov_b64 exec, -1
L_h1_cleared:
    s_nop 1
L_h1_noclear:
    v_add_u32 v23, 0, v3
    v_xor_b32 v23, v23, v22
    v_lshlrev_b32 v23, 4, v23
    v_lshl_add_u32 v12, v3, 8, v23
    v_add_u32 v23, 4, v3
    v_xor_b32 v23, v23, v22
    v_lshlrev_b32 v23, 4, v23
    v_lshl_add_u32 v13, v3, 8, v23
    v_add_u32 v23, 8, v3
    v_xor_b32 v23, v23, v22
    v_lshlrev_b32 v23, 4, v23
    v_lshl_add_u32 v14, v3, 8, v23
    v_add_u32 v23, 12, v3
    v_xor_b32 v23, v23, v22
    v_lshlrev_b32 v23, 4, v23
    v_lshl_add_u32 v15, v3, 8, v23
    v_add_u32 v23, 0, v3
    v_lshlrev_b32 v23, 1, v23
    v_xor_b32 v23, v23, v22
    v_lshlrev_b32 v23, 4, v23
    v_lshl_add_u32 v16, v3, 8, v23
    v_add_u32 v23, 4, v3
    v_lshlrev_b32 v23, 1, v23
    v_xor_b32 v23, v23, v22
    v_lshlrev_b32 v23, 4, v23
    v_lshl_add_u32 v17, v3, 8, v23
    s_lshl_b32 s74, s3, 15
    s_lshl_b32 s97, s3, 12
    s_lshl_b32 s75, s73, 19
    s_add_u32 s78, s75, s97
    s_add_u32 s79, s78, 32768
    v_mov_b32 v18, 157256
    s_lshl_b32 s75, s3, 2
    s_add_u32 s75, s75, 157200
    v_mov_b32 v19, s75
    v_mov_b32 v20, 2
    v_mov_b32 v23, 0
    s_waitcnt vmcnt(0)
    s_branch L_ln
L_helper_h1:
    v_mov_b32 v13, 0
    v_mov_b32 v14, 157184
    v_mov_b32 v15, 0
    v_mov_b32 v16, 0
    ds_write_b32 v14, v13
    ds_write_b32 v14, v13 offset:4
    ds_write_b32 v14, v13 offset:12
    s_lshl_b32 s75, s73, 4
    v_add_u32 v15, s75, v2
    v_cmp_gt_u32 vcc, 8, v2
    v_lshlrev_b32 v16, 2, v2
    v_add_u32 v16, 157248, v16
    v_cndmask_b32 v15, -1, v15, vcc
    v_mov_b32 v17, -1
    ds_write_b32 v16, v15
    s_mov_b64 exec, 0xffffffff
    ds_write_b32 v16, v17 offset:256
    s_mov_b64 exec, 15
    v_lshlrev_b32 v16, 2, v2
    v_add_u32 v16, 157200, v16
    ds_write_b32 v16, v13
    s_mov_b64 exec, -1
    s_waitcnt vmcnt(4)
L_ln:
    v_lshlrev_b32 v24, 16, v8
    v_and_b32 v25, 0xffff0000, v8
    v_lshlrev_b32 v26, 16, v9
    v_and_b32 v27, 0xffff0000, v9
    v_lshlrev_b32 v28, 16, v10
    v_and_b32 v29, 0xffff0000, v10
    v_lshlrev_b32 v30, 16, v11
    v_and_b32 v31, 0xffff0000, v11
    v_add_f32 v40, v24, v25
    v_add_f32 v40, v40, v26
    v_add_f32 v40, v40, v27
    v_add_f32 v40, v40, v28
    v_add_f32 v40, v40, v29
    v_add_f32 v40, v40, v30
    v_add_f32 v40, v40, v31
    s_nop 1
    v_add_f32_dpp v40, v40, v40 quad_perm:[1,0,3,2] row_mask:0xf bank_mask:0xf
    s_nop 1
    v_add_f32_dpp v40, v40, v40 quad_perm:[2,3,0,1] row_mask:0xf bank_mask:0xf
    s_nop 1
    v_add_f32_dpp v40, v40, v40 row_half_mirror row_mask:0xf bank_mask:0xf
    s_nop 1
    v_add_f32_dpp v40, v40, v40 row_mirror row_mask:0xf bank_mask:0xf
    s_nop 1
    v_readlane_b32 s92, v40, 0
    v_readlane_b32 s93, v40, 16
    v_readlane_b32 s94, v40, 32
    v_readlane_b32 s95, v40, 48
    s_nop 1
    v_mov_b32 v41, s92
    v_add_f32 v41, s93, v41
    v_add_f32 v40, s94, v41
    v_add_f32 v40, s95, v40
    v_mul_f32 v40, 0x3b000000, v40
    v_sub_f32 v42, v24, v40
    v_sub_f32 v43, v25, v40
    v_sub_f32 v44, v26, v40
    v_sub_f32 v45, v27, v40
    v_sub_f32 v46, v28, v40
    v_sub_f32 v47, v29, v40
    v_sub_f32 v48, v30, v40
    v_sub_f32 v49, v31, v40
    v_mul_f32 v50, v42, v42
    v_fmac_f32 v50, v43, v43
    v_fmac_f32 v50, v44, v44
    v_fmac_f32 v50, v45, v45
    v_fmac_f32 v50, v46, v46
    v_fmac_f32 v50, v47, v47
    v_fmac_f32 v50, v48, v48
    v_fmac_f32 v50, v49, v49
    s_nop 1
    v_add_f32_dpp v50, v50, v50 quad_perm:[1,0,3,2] row_mask:0xf bank_mask:0xf
    s_nop 1
    v_add_f32_dpp v50, v50, v50 quad_perm:[2,3,0,1] row_mask:0xf bank_mask:0xf
    s_nop 1
    v_add_f32_dpp v50, v50, v50 row_half_mirror row_mask:0xf bank_mask:0xf
    s_nop 1
    v_add_f32_dpp v50, v50, v50 row_mirror row_mask:0xf bank_mask:0xf
    s_nop 1
    v_readlane_b32 s92, v50, 0
    v_readlane_b32 s93, v50, 16
    v_readlane_b32 s94, v50, 32
    v_readlane_b32 s95, v50, 48
    s_nop 1
    v_mov_b32 v41, s92
    v_add_f32 v41, s93, v41
    v_add_f32 v50, s94, v41
    v_add_f32 v50, s95, v50
    v_mul_f32 v50, 0x3b000000, v50
    v_cvt_pk_bf16_f32 v50, v50, v50
    v_lshlrev_b32 v50, 16, v50
    v_add_f32 v50, 0x3727c5ac, v50
    v_cvt_pk_bf16_f32 v50, v50, v50
    v_lshlrev_b32 v50, 16, v50
    v_sqrt_f32 v50, v50
    s_nop 0
    v_cvt_pk_bf16_f32 v50, v50, v50
    v_lshlrev_b32 v50, 16, v50
    v_rcp_f32 v51, v50
    v_cvt_pk_bf16_f32 v40, v40, v40
    v_lshlrev_b32 v40, 16, v40
    v_sub_f32 v24, v24, v40
    v_sub_f32 v25, v25, v40
    v_sub_f32 v26, v26, v40
    v_sub_f32 v27, v27, v40
    v_sub_f32 v28, v28, v40
    v_sub_f32 v29, v29, v40
    v_sub_f32 v30, v30, v40
    v_sub_f32 v31, v31, v40
    v_cvt_pk_bf16_f32 v42, v24, v25
    v_lshlrev_b32 v24, 16, v42
    v_and_b32 v25, 0xffff0000, v42
    v_cvt_pk_bf16_f32 v42, v26, v27
    v_lshlrev_b32 v26, 16, v42
    v_and_b32 v27, 0xffff0000, v42
    v_cvt_pk_bf16_f32 v42, v28, v29
    v_lshlrev_b32 v28, 16, v42
    v_and_b32 v29, 0xffff0000, v42
    v_cvt_pk_bf16_f32 v42, v30, v31
    v_lshlrev_b32 v30, 16, v42
    v_and_b32 v31, 0xffff0000, v42
    v_mul_f32 v42, v24, v51
    v_fma_f32 v43, -v42, v50, v24
    v_fma_f32 v24, v43, v51, v42
    v_mul_f32 v42, v25, v51
    v_fma_f32 v43, -v42, v50, v25
    v_fma_f32 v25, v43, v51, v42
    v_mul_f32 v42, v26, v51
    v_fma_f32 v43, -v42, v50, v26
    v_fma_f32 v26, v43, v51, v42
    v_mul_f32 v42, v27, v51
    v_fma_f32 v43, -v42, v50, v27
    v_fma_f32 v27, v43, v51, v42
    v_mul_f32 v42, v28, v51
    v_fma_f32 v43, -v42, v50, v28
    v_fma_f32 v28, v43, v51, v42
    v_mul_f32 v42, v29, v51
    v_fma_f32 v43, -v42, v50, v29
    v_fma_f32 v29, v43, v51, v42
    v_mul_f32 v42, v30, v51
    v_fma_f32 v43, -v42, v50, v30
    v_fma_f32 v30, v43, v51, v42
    v_mul_f32 v42, v31, v51
    v_fma_f32 v43, -v42, v50, v31
    v_fma_f32 v31, v43, v51, v42
    v_cvt_pk_bf16_f32 v42, v24, v25
    v_lshlrev_b32 v24, 16, v42
    v_and_b32 v25, 0xffff0000, v42
    v_cvt_pk_bf16_f32 v42, v26, v27
    v_lshlrev_b32 v26, 16, v42
    v_and_b32 v27, 0xffff0000, v42
    v_cvt_pk_bf16_f32 v42, v28, v29
    v_lshlrev_b32 v28, 16, v42
    v_and_b32 v29, 0xffff0000, v42
    v_cvt_pk_bf16_f32 v42, v30, v31
    v_lshlrev_b32 v30, 16, v42
    v_and_b32 v31, 0xffff0000, v42
    v_cvt_pk_bf16_f32 v32, v24, v25
    v_cvt_pk_bf16_f32 v33, v26, v27
    v_cvt_pk_bf16_f32 v34, v28, v29
    v_cvt_pk_bf16_f32 v35, v30, v31
    s_lshl_b32 s75, s3, 10
    s_add_u32 s75, s75, 131072
    v_add_u32 v6, s75, v5
    ds_write_b128 v6, v[32:35]
    s_cmp_lt_u32 s3, 4
    s_cbranch_scc1 L_b1_s
    s_waitcnt vmcnt(0)
L_b1_s:
    s_waitcnt lgkmcnt(0)
    s_barrier
    s_cmp_lt_u32 s3, 4
    s_cbranch_scc1 L_s_pre
    s_cmp_lg_u32 s3, 4
    s_cbranch_scc1 L_table
    v_bfe_u32 v4, v2, 2, 2
    v_and_b32 v5, 3, v2
    v_lshl_add_u32 v6, v3, 3, v4
    v_lshlrev_b32 v6, 5, v6
    v_lshl_add_u32 v6, v5, 3, v6
    v_add_u32 v6, 139264, v6
    v_and_b32 v7, 7, v2
    v_lshlrev_b32 v7, 10, v7
    v_lshl_add_u32 v7, v3, 4, v7
    v_add_u32 v7, 131072, v7
    ds_read_b64_tr_b16 v[32:33], v6 offset:0
    ds_read_b64_tr_b16 v[34:35], v6 offset:128
    ds_read_b128 v[112:115], v7 offset:0
    ds_read_b64_tr_b16 v[36:37], v6 offset:1024
    ds_read_b64_tr_b16 v[38:39], v6 offset:1152
    ds_read_b128 v[116:119], v7 offset:64
    ds_read_b64_tr_b16 v[40:41], v6 offset:2048
    ds_read_b64_tr_b16 v[42:43], v6 offset:2176
    ds_read_b128 v[120:123], v7 offset:128
    ds_read_b64_tr_b16 v[44:45], v6 offset:3072
    ds_read_b64_tr_b16 v[46:47], v6 offset:3200
    ds_read_b128 v[124:127], v7 offset:192
    s_waitcnt lgkmcnt(0)
    ds_read_b64_tr_b16 v[48:49], v6 offset:4096
    ds_read_b64_tr_b16 v[50:51], v6 offset:4224
    ds_read_b128 v[128:131], v7 offset:256
    ds_read_b64_tr_b16 v[52:53], v6 offset:5120
    ds_read_b64_tr_b16 v[54:55], v6 offset:5248
    ds_read_b128 v[132:135], v7 offset:320
    ds_read_b64_tr_b16 v[56:57], v6 offset:6144
    ds_read_b64_tr_b16 v[58:59], v6 offset:6272
    ds_read_b128 v[136:139], v7 offset:384
    ds_read_b64_tr_b16 v[60:61], v6 offset:7168
    ds_read_b64_tr_b16 v[62:63], v6 offset:7296
    ds_read_b128 v[140:143], v7 offset:448
    s_waitcnt lgkmcnt(0)
    v_mfma_f32_16x16x32_bf16 v[8:11], v[32:35], v[112:115], 0
    v_mfma_f32_16x16x32_bf16 v[8:11], v[36:39], v[116:119], v[8:11]
    v_mfma_f32_16x16x32_bf16 v[8:11], v[40:43], v[120:123], v[8:11]
    v_mfma_f32_16x16x32_bf16 v[8:11], v[44:47], v[124:127], v[8:11]
    v_mfma_f32_16x16x32_bf16 v[8:11], v[48:51], v[128:131], v[8:11]
    v_mfma_f32_16x16x32_bf16 v[8:11], v[52:55], v[132:135], v[8:11]
    v_mfma_f32_16x16x32_bf16 v[8:11], v[56:59], v[136:139], v[8:11]
    v_mfma_f32_16x16x32_bf16 v[8:11], v[60:63], v[140:143], v[8:11]
    s_nop 7
    ds_read_b64_tr_b16 v[64:65], v6 offset:8192
    ds_read_b64_tr_b16 v[66:67], v6 offset:8320
    ds_read_b128 v[112:115], v7 offset:512
    ds_read_b64_tr_b16 v[68:69], v6 offset:9216
    ds_read_b64_tr_b16 v[70:71], v6 offset:9344
    ds_read_b128 v[116:119], v7 offset:576
    ds_read_b64_tr_b16 v[72:73], v6 offset:10240
    ds_read_b64_tr_b16 v[74:75], v6 offset:10368
    ds_read_b128 v[120:123], v7 offset:640
    ds_read_b64_tr_b16 v[76:77], v6 offset:11264
    ds_read_b64_tr_b16 v[78:79], v6 offset:11392
    ds_read_b128 v[124:127], v7 offset:704
    s_waitcnt lgkmcnt(0)
    ds_read_b64_tr_b16 v[80:81], v6 offset:12288
    ds_read_b64_tr_b16 v[82:83], v6 offset:12416
    ds_read_b128 v[128:131], v7 offset:768
    ds_read_b64_tr_b16 v[84:85], v6 offset:13312
    ds_read_b64_tr_b16 v[86:87], v6 offset:13440
    ds_read_b128 v[132:135], v7 offset:832
    ds_read_b64_tr_b16 v[88:89], v6 offset:14336
    ds_read_b64_tr_b16 v[90:91], v6 offset:14464
    ds_read_b128 v[136:139], v7 offset:896
    ds_read_b64_tr_b16 v[92:93], v6 offset:15360
    ds_read_b64_tr_b16 v[94:95], v6 offset:15488
    ds_read_b128 v[140:143], v7 offset:960
    s_waitcnt lgkmcnt(0)
    v_mfma_f32_16x16x32_bf16 v[8:11], v[64:67], v[112:115], v[8:11]
    v_mfma_f32_16x16x32_bf16 v[8:11], v[68:71], v[116:119], v[8:11]
    v_mfma_f32_16x16x32_bf16 v[8:11], v[72:75], v[120:123], v[8:11]
    v_mfma_f32_16x16x32_bf16 v[8:11], v[76:79], v[124:127], v[8:11]
    v_mfma_f32_16x16x32_bf16 v[8:11], v[80:83], v[128:131], v[8:11]
    v_mfma_f32_16x16x32_bf16 v[8:11], v[84:87], v[132:135], v[8:11]
    v_mfma_f32_16x16x32_bf16 v[8:11], v[88:91], v[136:139], v[8:11]
    v_mfma_f32_16x16x32_bf16 v[8:11], v[92:95], v[140:143], v[8:11]
    s_memrealtime s[76:77]
    v_lshlrev_b32 v5, 6, v22
    v_lshl_add_u32 v5, v3, 4, v5
    s_lshl_b32 s75, s88, 9
    s_add_u32 s75, s75, 1048576
    s_nop 4
    s_waitcnt lgkmcnt(0)
    v_cvt_pk_bf16_f32 v12, v8, v9
    v_cvt_pk_bf16_f32 v13, v10, v11
    v_mov_b32 v14, s76
    v_mov_b32 v15, s77
    v_cmp_gt_u32 vcc, 8, v22
    s_and_saveexec_b64 s[82:83], vcc
    buffer_store_dwordx4 v[12:15], v5, s[40:43], s75 offen sc1
    s_mov_b64 exec, s[82:83]
    v_lshrrev_b32 v5, 1, v2
    v_lshlrev_b32 v5, 9, v5
    v_and_b32 v6, 1, v2
    v_lshl_add_u32 v5, v6, 5, v5
    s_and_b32 s75, s72, 7
    s_lshl_b32 s75, s75, 14
    s_lshr_b32 s76, s72, 3
    s_lshl_b32 s76, s76, 6
    s_add_u32 s75, s75, s76
    s_add_u32 s75, s75, 1048576
    s_sub_u32 s30, s30, 2000
    s_subb_u32 s31, s31, 0
    v_mov_b32 v20, s31
    v_mov_b32 v24, s88
    v_mov_b32 v25, 1
    s_and_b32 s76, s72, 7
    s_lshl_b32 s76, s76, 5
    v_and_b32 v26, 7, v2
    v_lshlrev_b32 v26, 2, v26
    v_add_u32 v26, s76, v26
    s_mov_b32 s90, 0
    s_mov_b32 s91, 0x01010101
    s_mov_b32 s77, 0
    s_mov_b32 s76, 0x100000
L_qpoll:
    buffer_load_dwordx4 v[8:11], v5, s[40:43], s75 offen sc1
    buffer_load_dwordx4 v[16:19], v5, s[40:43], s75 offen offset:16 sc1
    s_waitcnt vmcnt(0)
    s_cmp_lg_u32 s77, 0
    s_cbranch_scc1 L_qflagged
    s_mov_b32 s77, 1
    s_mov_b64 exec, 1
    global_store_byte v24, v25, s[26:27] sc1
    s_mov_b64 exec, -1
L_qflagged:
    v_subrev_co_u32 v21, vcc, s30, v10
    s_nop 1
    v_subb_co_u32 v23, vcc, v11, v20, vcc
    v_subrev_co_u32 v27, vcc, s30, v18
    s_nop 1
    v_subb_co_u32 v28, vcc, v19, v20, vcc
    v_or_b32 v23, v23, v28
    v_max_u32 v21, v21, v27
    v_cmp_ne_u32 vcc, 0, v23
    v_cmp_le_u32 s[82:83], s76, v21
    s_or_b64 vcc, vcc, s[82:83]
    s_cmp_eq_u64 vcc, 0
    s_cbranch_scc1 L_qready
    s_add_u32 s90, s90, 1
    s_cmp_ge_u32 s90, 400000
    s_cbranch_scc1 L_qready
    s_and_b32 s82, s90, 63
    s_cmp_lg_u32 s82, 0
    s_cbranch_scc1 L_qsleep
    global_load_dword v21, v26, s[26:27] sc1
    s_waitcnt vmcnt(0)
    v_cmp_ne_u32 vcc, s91, v21
    s_nop 1
    s_cmp_lg_u64 vcc, 0
    s_cbranch_scc1 L_qsleep
    buffer_load_dwordx4 v[8:11], v5, s[40:43], s75 offen sc1
    buffer_load_dwordx4 v[16:19], v5, s[40:43], s75 offen offset:16 sc1
    s_waitcnt vmcnt(0)
    s_branch L_qready
L_qsleep:
    s_sleep 1
    s_branch L_qpoll
L_qready:
    v_mov_b32 v10, v16
    v_mov_b32 v11, v17
    v_lshlrev_b32 v6, 4, v2
    v_add_u32 v6, 155648, v6
    ds_write_b128 v6, v[8:11]
    s_waitcnt lgkmcnt(0)
    v_mov_b32 v14, 157184
    v_mov_b32 v15, 1
    ds_write_b32 v14, v15
    v_lshrrev_b32 v12, 2, v2
    v_lshlrev_b32 v12, 10, v12
    v_and_b32 v13, 3, v2
    v_lshl_add_u32 v12, v13, 4, v12
    s_lshr_b32 s75, s2, 4
    s_lshl_b32 s75, s75, 18
    s_and_b32 s76, s2, 7
    s_lshl_b32 s76, s76, 7
    s_add_u32 s75, s75, s76
    s_bfe_u32 s76, s2, 0x10003
    s_lshl_b32 s76, s76, 6
    s_add_u32 s75, s75, s76
    s_mov_b32 s76, 139264
    s_mov_b32 m0, s76
    s_nop 0
    buffer_load_dwordx4 v12, s[84:87], s75 offen lds
    s_add_u32 s76, s76, 1024
    s_add_u32 s75, s75, 16384
    s_mov_b32 m0, s76
    s_nop 0
    buffer_load_dwordx4 v12, s[84:87], s75 offen lds
    s_add_u32 s76, s76, 1024
    s_add_u32 s75, s75, 16384
    s_mov_b32 m0, s76
    s_nop 0
    buffer_load_dwordx4 v12, s[84:87], s75 offen lds
    s_add_u32 s76, s76, 1024
    s_add_u32 s75, s75, 16384
    s_mov_b32 m0, s76
    s_nop 0
    buffer_load_dwordx4 v12, s[84:87], s75 offen lds
    s_add_u32 s76, s76, 1024
    s_add_u32 s75, s75, 16384
    s_mov_b32 m0, s76
    s_nop 0
    buffer_load_dwordx4 v12, s[84:87], s75 offen lds
    s_add_u32 s76, s76, 1024
    s_add_u32 s75, s75, 16384
    s_mov_b32 m0, s76
    s_nop 0
    buffer_load_dwordx4 v12, s[84:87], s75 offen lds
    s_add_u32 s76, s76, 1024
    s_add_u32 s75, s75, 16384
    s_mov_b32 m0, s76
    s_nop 0
    buffer_load_dwordx4 v12, s[84:87], s75 offen lds
    s_add_u32 s76, s76, 1024
    s_add_u32 s75, s75, 16384
    s_mov_b32 m0, s76
    s_nop 0
    buffer_load_dwordx4 v12, s[84:87], s75 offen lds
    s_add_u32 s76, s76, 1024
    s_add_u32 s75, s75, 16384
    s_mov_b32 m0, s76
    s_nop 0
    buffer_load_dwordx4 v12, s[84:87], s75 offen lds
    s_add_u32 s76, s76, 1024
    s_add_u32 s75, s75, 16384
    s_mov_b32 m0, s76
    s_nop 0
    buffer_load_dwordx4 v12, s[84:87], s75 offen lds
    s_add_u32 s76, s76, 1024
    s_add_u32 s75, s75, 16384
    s_mov_b32 m0, s76
    s_nop 0
    buffer_load_dwordx4 v12, s[84:87], s75 offen lds
    s_add_u32 s76, s76, 1024
    s_add_u32 s75, s75, 16384
    s_mov_b32 m0, s76
    s_nop 0
    buffer_load_dwordx4 v12, s[84:87], s75 offen lds
    s_add_u32 s76, s76, 1024
    s_add_u32 s75, s75, 16384
    s_mov_b32 m0, s76
    s_nop 0
    buffer_load_dwordx4 v12, s[84:87], s75 offen lds
    s_add_u32 s76, s76, 1024
    s_add_u32 s75, s75, 16384
    s_mov_b32 m0, s76
    s_nop 0
    buffer_load_dwordx4 v12, s[84:87], s75 offen lds
    s_add_u32 s76, s76, 1024
    s_add_u32 s75, s75, 16384
    s_mov_b32 m0, s76
    s_nop 0
    buffer_load_dwordx4 v12, s[84:87], s75 offen lds
    s_add_u32 s76, s76, 1024
    s_add_u32 s75, s75, 16384
    s_mov_b32 m0, s76
    s_nop 0
    buffer_load_dwordx4 v12, s[84:87], s75 offen lds
    s_branch L_table
L_s_pre:
    v_mov_b32 v23, 0
    s_add_u32 s76, s74, 0
    s_mov_b32 m0, s76
    s_mov_b32 s77, s78
    buffer_load_dwordx4 v12, s[32:35], s77 offen offset:0 nt lds
    buffer_load_dwordx4 v13, s[32:35], s77 offen offset:1024 nt lds
    buffer_load_dwordx4 v14, s[32:35], s77 offen offset:2048 nt lds
    buffer_load_dwordx4 v15, s[32:35], s77 offen offset:3072 nt lds
    s_add_u32 s76, s74, 4096
    s_mov_b32 m0, s76
    s_add_u32 s77, s78, 16384
    buffer_load_dwordx4 v12, s[32:35], s77 offen offset:0 nt lds
    buffer_load_dwordx4 v13, s[32:35], s77 offen offset:1024 nt lds
    buffer_load_dwordx4 v14, s[32:35], s77 offen offset:2048 nt lds
    buffer_load_dwordx4 v15, s[32:35], s77 offen offset:3072 nt lds
    v_add_u32 v23, 0, v3
    v_xor_b32 v23, v23, v22
    v_lshlrev_b32 v23, 4, v23
    v_lshl_add_u32 v23, v22, 8, v23
    v_add_u32 v24, s74, v23
    v_add_u32 v23, 4, v3
    v_xor_b32 v23, v23, v22
    v_lshlrev_b32 v23, 4, v23
    v_lshl_add_u32 v23, v22, 8, v23
    v_add_u32 v25, s74, v23
    v_add_u32 v23, 8, v3
    v_xor_b32 v23, v23, v22
    v_lshlrev_b32 v23, 4, v23
    v_lshl_add_u32 v23, v22, 8, v23
    v_add_u32 v26, s74, v23
    v_add_u32 v23, 12, v3
    v_xor_b32 v23, v23, v22
    v_lshlrev_b32 v23, 4, v23
    v_lshl_add_u32 v23, v22, 8, v23
    v_add_u32 v27, s74, v23
    v_bfe_u32 v40, v2, 2, 2
    v_lshl_add_u32 v40, v3, 2, v40
    v_and_b32 v41, 7, v40
    v_lshlrev_b32 v41, 1, v41
    v_bfe_u32 v42, v2, 1, 1
    v_and_b32 v43, 1, v2
    v_lshlrev_b32 v44, 8, v40
    v_lshl_add_u32 v44, v43, 3, v44
    v_add_u32 v44, s74, v44
    v_add_u32 v44, 16384, v44
    v_xor_b32 v23, 0, v41
    v_add_u32 v23, v23, v42
    v_lshl_add_u32 v28, v23, 4, v44
    v_xor_b32 v23, 2, v41
    v_add_u32 v23, v23, v42
    v_lshl_add_u32 v29, v23, 4, v44
    v_xor_b32 v23, 4, v41
    v_add_u32 v23, v23, v42
    v_lshl_add_u32 v30, v23, 4, v44
    v_xor_b32 v23, 6, v41
    v_add_u32 v23, v23, v42
    v_lshl_add_u32 v31, v23, 4, v44
    v_xor_b32 v23, 8, v41
    v_add_u32 v23, v23, v42
    v_lshl_add_u32 v32, v23, 4, v44
    v_xor_b32 v23, 10, v41
    v_add_u32 v23, v23, v42
    v_lshl_add_u32 v33, v23, 4, v44
    v_xor_b32 v23, 12, v41
    v_add_u32 v23, v23, v42
    v_lshl_add_u32 v34, v23, 4, v44
    v_xor_b32 v23, 14, v41
    v_add_u32 v23, v23, v42
    v_lshl_add_u32 v35, v23, 4, v44
    v_mov_b32 v144, 0
    v_mov_b32 v145, 0
    v_mov_b32 v146, 0
    v_mov_b32 v147, 0
    v_mov_b32 v148, 0
    v_mov_b32 v149, 0
    v_mov_b32 v150, 0
    v_mov_b32 v151, 0
    v_mov_b32 v152, 0
    v_mov_b32 v153, 0
    v_mov_b32 v154, 0
    v_mov_b32 v155, 0
    v_mov_b32 v156, 0
    v_mov_b32 v157, 0
    v_mov_b32 v158, 0
    v_mov_b32 v159, 0
    v_mov_b32 v160, 0
    v_mov_b32 v161, 0
    v_mov_b32 v162, 0
    v_mov_b32 v163, 0
    v_mov_b32 v164, 0
    v_mov_b32 v165, 0
    v_mov_b32 v166, 0
    v_mov_b32 v167, 0
    v_mov_b32 v168, 0
    v_mov_b32 v169, 0
    v_mov_b32 v170, 0
    v_mov_b32 v171, 0
    v_mov_b32 v172, 0
    v_mov_b32 v173, 0
    v_mov_b32 v174, 0
    v_mov_b32 v175, 0
    v_mov_b32 v36, 0
    v_mov_b32 v37, 0
    v_mov_b32 v38, 0
    v_mov_b32 v39, 0
    v_mov_b32 v40, 0
    v_mov_b32 v41, 0
    v_mov_b32 v42, 0
    v_mov_b32 v43, 0
    v_mov_b32 v44, 0
    v_mov_b32 v45, 0
    v_mov_b32 v46, 0
    v_mov_b32 v47, 0
    v_mov_b32 v48, 0
    v_mov_b32 v49, 0
    v_mov_b32 v50, 0
    v_mov_b32 v51, 0
    v_mov_b32 v136, 0xf149f2ca
    v_mov_b32 v138, 0xf149f2ca
    v_mov_b32 v137, 0
    v_mov_b32 v139, 0
    v_xor_b32 v140, 16, v2
    v_lshlrev_b32 v140, 2, v140
    v_xor_b32 v141, 32, v2
    v_lshlrev_b32 v141, 2, v141
    v_lshlrev_b32 v4, 8, v22
    v_lshl_add_u32 v4, v3, 4, v4
    v_add_u32 v4, 155648, v4
    v_mov_b32 v23, 0
    v_mov_b32 v5, 157184
    s_mov_b32 s90, 0
L_pw1:
    ds_read_b32 v6, v5
    s_waitcnt lgkmcnt(0)
    v_readfirstlane_b32 s75, v6
    s_cmp_lg_u32 s75, 0
    s_cbranch_scc1 L_pg1
    s_add_u32 s90, s90, 1
    s_cmp_ge_u32 s90, 8
    s_cbranch_scc1 L_pg1
    s_sleep 1
    s_branch L_pw1
L_pg1:
    s_add_u32 s76, s74, 16384
    s_mov_b32 m0, s76
    s_mov_b32 s77, s78
    buffer_load_dwordx4 v16, s[36:39], s77 offen offset:0 nt lds
    buffer_load_dwordx4 v17, s[36:39], s77 offen offset:1024 nt lds
    buffer_load_dwordx4 v16, s[36:39], s77 offen offset:2048 nt lds
    buffer_load_dwordx4 v17, s[36:39], s77 offen offset:3072 nt lds
    s_add_u32 s76, s74, 20480
    s_mov_b32 m0, s76
    s_add_u32 s77, s78, 16384
    buffer_load_dwordx4 v16, s[36:39], s77 offen offset:0 nt lds
    buffer_load_dwordx4 v17, s[36:39], s77 offen offset:1024 nt lds
    buffer_load_dwordx4 v16, s[36:39], s77 offen offset:2048 nt lds
    buffer_load_dwordx4 v17, s[36:39], s77 offen offset:3072 nt lds
    s_mov_b32 s90, 0
L_pw2:
    ds_read_b32 v6, v5
    s_waitcnt lgkmcnt(0)
    v_readfirstlane_b32 s75, v6
    s_cmp_lg_u32 s75, 0
    s_cbranch_scc1 L_pg2
    s_add_u32 s90, s90, 1
    s_cmp_ge_u32 s90, 8
    s_cbranch_scc1 L_pg2
    s_sleep 1
    s_branch L_pw2
L_pg2:
    s_add_u32 s76, s74, 8192
    s_mov_b32 m0, s76
    s_mov_b32 s77, s79
    buffer_load_dwordx4 v12, s[32:35], s77 offen offset:0 nt lds
    buffer_load_dwordx4 v13, s[32:35], s77 offen offset:1024 nt lds
    buffer_load_dwordx4 v14, s[32:35], s77 offen offset:2048 nt lds
    buffer_load_dwordx4 v15, s[32:35], s77 offen offset:3072 nt lds
    s_add_u32 s76, s74, 12288
    s_mov_b32 m0, s76
    s_add_u32 s77, s79, 16384
    buffer_load_dwordx4 v12, s[32:35], s77 offen offset:0 nt lds
    buffer_load_dwordx4 v13, s[32:35], s77 offen offset:1024 nt lds
    buffer_load_dwordx4 v14, s[32:35], s77 offen offset:2048 nt lds
    buffer_load_dwordx4 v15, s[32:35], s77 offen offset:3072 nt lds
    s_mov_b32 s90, 0
L_pw3:
    ds_read_b32 v6, v5
    s_waitcnt lgkmcnt(0)
    v_readfirstlane_b32 s75, v6
    s_cmp_lg_u32 s75, 0
    s_cbranch_scc1 L_pg3
    s_add_u32 s90, s90, 1
    s_cmp_ge_u32 s90, 8
    s_cbranch_scc1 L_pg3
    s_sleep 1
    s_branch L_pw3
L_pg3:
    s_add_u32 s76, s74, 24576
    s_mov_b32 m0, s76
    s_mov_b32 s77, s79
    buffer_load_dwordx4 v16, s[36:39], s77 offen offset:0 nt lds
    buffer_load_dwordx4 v17, s[36:39], s77 offen offset:1024 nt lds
    buffer_load_dwordx4 v16, s[36:39], s77 offen offset:2048 nt lds
    buffer_load_dwordx4 v17, s[36:39], s77 offen offset:3072 nt lds
    s_add_u32 s76, s74, 28672
    s_mov_b32 m0, s76
    s_add_u32 s77, s79, 16384
    buffer_load_dwordx4 v16, s[36:39], s77 offen offset:0 nt lds
    buffer_load_dwordx4 v17, s[36:39], s77 offen offset:1024 nt lds
    buffer_load_dwordx4 v16, s[36:39], s77 offen offset:2048 nt lds
    buffer_load_dwordx4 v17, s[36:39], s77 offen offset:3072 nt lds
    s_mov_b32 s90, 0
L_pw9:
    ds_read_b32 v6, v5
    s_waitcnt lgkmcnt(0)
    v_readfirstlane_b32 s75, v6
    s_cmp_lg_u32 s75, 0
    s_cbranch_scc1 L_pg9
    s_add_u32 s90, s90, 1
    s_cmp_ge_u32 s90, 8
    s_cbranch_scc1 L_pg9
    s_sleep 1
    s_branch L_pw9
L_pg9:
    s_add_u32 s76, s78, 65536
    s_add_u32 s77, s76, 16384
    buffer_load_dwordx4 v[176:179], v12, s[32:35], s76 offen offset:0 nt
    buffer_load_dwordx4 v[180:183], v13, s[32:35], s76 offen offset:1024 nt
    buffer_load_dwordx4 v[184:187], v14, s[32:35], s76 offen offset:2048 nt
    buffer_load_dwordx4 v[188:191], v15, s[32:35], s76 offen offset:3072 nt
    buffer_load_dwordx4 v[192:195], v12, s[32:35], s77 offen offset:0 nt
    buffer_load_dwordx4 v[196:199], v13, s[32:35], s77 offen offset:1024 nt
    buffer_load_dwordx4 v[200:203], v14, s[32:35], s77 offen offset:2048 nt
    buffer_load_dwordx4 v[204:207], v15, s[32:35], s77 offen offset:3072 nt
    buffer_load_dwordx4 v[208:211], v16, s[36:39], s76 offen offset:0 nt
    buffer_load_dwordx4 v[212:215], v17, s[36:39], s76 offen offset:1024 nt
    buffer_load_dwordx4 v[216:219], v16, s[36:39], s76 offen offset:2048 nt
    buffer_load_dwordx4 v[220:223], v17, s[36:39], s76 offen offset:3072 nt
    buffer_load_dwordx4 v[224:227], v16, s[36:39], s77 offen offset:0 nt
    buffer_load_dwordx4 v[228:231], v17, s[36:39], s77 offen offset:1024 nt
    buffer_load_dwordx4 v[232:235], v16, s[36:39], s77 offen offset:2048 nt
    buffer_load_dwordx4 v[236:239], v17, s[36:39], s77 offen offset:3072 nt
    v_lshlrev_b32 v240, 4, v2
    v_add_u32 v240, s74, v240
    s_mov_b32 s99, 1
    v_mov_b32 v5, 157184
    s_mov_b32 s90, 0
L_qwait:
    ds_read_b32 v6, v5
    s_waitcnt lgkmcnt(0)
    v_readfirstlane_b32 s75, v6
    s_cmp_lg_u32 s75, 0
    s_cbranch_scc1 L_qhere
    s_add_u32 s90, s90, 1
    s_cmp_ge_u32 s90, 8000000
    s_cbranch_scc1 L_qhere
    s_sleep 1
    s_branch L_qwait
L_qhere:
    v_cmp_gt_u32 vcc, 4, v22
    s_and_saveexec_b64 s[82:83], vcc
    ds_read_b128 v[36:39], v4 offset:0
    ds_read_b128 v[40:43], v4 offset:64
    ds_read_b128 v[44:47], v4 offset:128
    ds_read_b128 v[48:51], v4 offset:192
    s_mov_b64 exec, s[82:83]
    s_waitcnt lgkmcnt(0)
    s_setprio 2
L_loop:
    s_waitcnt vmcnt(24)
    ds_read_b128 v[52:55], v24 offset:0
    ds_read_b128 v[56:59], v25 offset:0
    ds_read_b128 v[60:63], v26 offset:0
    ds_read_b128 v[64:67], v27 offset:0
    ds_read_b128 v[68:71], v24 offset:4096
    ds_read_b128 v[72:75], v25 offset:4096
    ds_read_b128 v[76:79], v26 offset:4096
    ds_read_b128 v[80:83], v27 offset:4096
    ds_write_b32 v19, v20
    s_mov_b32 s90, 0
L_qq0:
    ds_read_b32 v21, v18
    s_waitcnt lgkmcnt(0)
    v_readfirstlane_b32 s75, v21
    s_add_u32 s90, s90, 1
    s_cmp_lt_u32 s90, 0x1000000
    s_cselect_b32 s75, s75, 64
    s_cmp_eq_u32 s75, -1
    s_cbranch_scc1 L_qq0
    v_add_u32 v18, 4, v18
    v_add_u32 v20, 1, v20
    s_lshl_b32 s75, s75, 15
    s_add_u32 s78, s75, s97
    s_cmp_eq_u32 s99, 0
    s_cbranch_scc1 L_rk0
    s_waitcnt vmcnt(0)
    ds_write_b128 v240, v[176:179] offset:0
    ds_write_b128 v240, v[180:183] offset:1024
    ds_write_b128 v240, v[184:187] offset:2048
    ds_write_b128 v240, v[188:191] offset:3072
    ds_write_b128 v240, v[192:195] offset:4096
    ds_write_b128 v240, v[196:199] offset:5120
    ds_write_b128 v240, v[200:203] offset:6144
    ds_write_b128 v240, v[204:207] offset:7168
    s_branch L_rk1
L_rk0:
    s_add_u32 s76, s74, 0
    s_mov_b32 m0, s76
    s_mov_b32 s77, s78
    buffer_load_dwordx4 v12, s[32:35], s77 offen offset:0 nt lds
    buffer_load_dwordx4 v13, s[32:35], s77 offen offset:1024 nt lds
    buffer_load_dwordx4 v14, s[32:35], s77 offen offset:2048 nt lds
    buffer_load_dwordx4 v15, s[32:35], s77 offen offset:3072 nt lds
    s_add_u32 s76, s74, 4096
    s_mov_b32 m0, s76
    s_add_u32 s77, s78, 16384
    buffer_load_dwordx4 v12, s[32:35], s77 offen offset:0 nt lds
    buffer_load_dwordx4 v13, s[32:35], s77 offen offset:1024 nt lds
    buffer_load_dwordx4 v14, s[32:35], s77 offen offset:2048 nt lds
    buffer_load_dwordx4 v15, s[32:35], s77 offen offset:3072 nt lds
L_rk1:
    v_mfma_f32_16x16x32_bf16 v[116:119], v[52:55], v[36:39], 0
    v_mfma_f32_16x16x32_bf16 v[120:123], v[68:71], v[36:39], 0
    v_mfma_f32_16x16x32_bf16 v[116:119], v[56:59], v[40:43], v[116:119]
    v_mfma_f32_16x16x32_bf16 v[120:123], v[72:75], v[40:43], v[120:123]
    v_mfma_f32_16x16x32_bf16 v[116:119], v[60:63], v[44:47], v[116:119]
    v_mfma_f32_16x16x32_bf16 v[120:123], v[76:79], v[44:47], v[120:123]
    v_mfma_f32_16x16x32_bf16 v[116:119], v[64:67], v[48:51], v[116:119]
    v_mfma_f32_16x16x32_bf16 v[120:123], v[80:83], v[48:51], v[120:123]
    s_nop 7
    v_cvt_pk_bf16_f32 v128, v116, v117
    v_cvt_pk_bf16_f32 v129, v118, v119
    v_cvt_pk_bf16_f32 v130, v120, v121
    v_cvt_pk_bf16_f32 v131, v122, v123
    v_lshlrev_b32 v116, 16, v128
    v_and_b32 v117, 0xffff0000, v128
    v_lshlrev_b32 v118, 16, v129
    v_and_b32 v119, 0xffff0000, v129
    v_lshlrev_b32 v120, 16, v130
    v_and_b32 v121, 0xffff0000, v130
    v_lshlrev_b32 v122, 16, v131
    v_and_b32 v123, 0xffff0000, v131
    v_mul_f32 v116, s80, v116
    v_mul_f32 v117, s80, v117
    v_mul_f32 v118, s80, v118
    v_mul_f32 v119, s80, v119
    v_mul_f32 v120, s80, v120
    v_mul_f32 v121, s80, v121
    v_mul_f32 v122, s80, v122
    v_mul_f32 v123, s80, v123
    v_cvt_pk_bf16_f32 v128, v116, v117
    v_cvt_pk_bf16_f32 v129, v118, v119
    v_cvt_pk_bf16_f32 v130, v120, v121
    v_cvt_pk_bf16_f32 v131, v122, v123
    v_lshlrev_b32 v116, 16, v128
    v_and_b32 v117, 0xffff0000, v128
    v_lshlrev_b32 v118, 16, v129
    v_and_b32 v119, 0xffff0000, v129
    v_lshlrev_b32 v120, 16, v130
    v_and_b32 v121, 0xffff0000, v130
    v_lshlrev_b32 v122, 16, v131
    v_and_b32 v123, 0xffff0000, v131
    v_max3_f32 v128, v116, v117, v118
    v_max3_f32 v129, v119, v120, v121
    v_max3_f32 v128, v128, v122, v123
    v_max_f32 v128, v128, v129
    v_cmp_gt_f32 vcc, v128, v138
    s_cbranch_vccnz L_rare0
L_back0:
    v_fma_f32 v116, v116, s81, v137
    v_fma_f32 v117, v117, s81, v137
    v_fma_f32 v118, v118, s81, v137
    v_fma_f32 v119, v119, s81, v137
    v_fma_f32 v120, v120, s81, v137
    v_fma_f32 v121, v121, s81, v137
    v_fma_f32 v122, v122, s81, v137
    v_fma_f32 v123, v123, s81, v137
    v_exp_f32 v116, v116
    v_exp_f32 v117, v117
    v_exp_f32 v118, v118
    v_exp_f32 v119, v119
    v_exp_f32 v120, v120
    v_exp_f32 v121, v121
    v_exp_f32 v122, v122
    v_exp_f32 v123, v123
    s_nop 0
    v_cvt_pk_bf16_f32 v124, v116, v117
    v_cvt_pk_bf16_f32 v125, v118, v119
    v_cvt_pk_bf16_f32 v126, v120, v121
    v_cvt_pk_bf16_f32 v127, v122, v123
    v_add_f32 v128, v116, v117
    v_add_f32 v129, v118, v119
    v_add_f32 v130, v120, v121
    v_add_f32 v131, v122, v123
    v_add_f32 v128, v128, v129
    v_add_f32 v130, v130, v131
    v_add_f32 v128, v128, v130
    v_add_f32 v139, v139, v128
    s_waitcnt vmcnt(24)
    ds_read_b64_tr_b16 v[84:85], v28 offset:0
    ds_read_b64_tr_b16 v[86:87], v28 offset:4096
    ds_read_b64_tr_b16 v[88:89], v29 offset:0
    ds_read_b64_tr_b16 v[90:91], v29 offset:4096
    ds_read_b64_tr_b16 v[92:93], v30 offset:0
    ds_read_b64_tr_b16 v[94:95], v30 offset:4096
    ds_read_b64_tr_b16 v[96:97], v31 offset:0
    ds_read_b64_tr_b16 v[98:99], v31 offset:4096
    ds_read_b64_tr_b16 v[100:101], v32 offset:0
    ds_read_b64_tr_b16 v[102:103], v32 offset:4096
    ds_read_b64_tr_b16 v[104:105], v33 offset:0
    ds_read_b64_tr_b16 v[106:107], v33 offset:4096
    ds_read_b64_tr_b16 v[108:109], v34 offset:0
    ds_read_b64_tr_b16 v[110:111], v34 offset:4096
    ds_read_b64_tr_b16 v[112:113], v35 offset:0
    ds_read_b64_tr_b16 v[114:115], v35 offset:4096
    s_waitcnt lgkmcnt(0)
    s_cmp_eq_u32 s99, 0
    s_cbranch_scc1 L_rv0
    ds_write_b128 v240, v[208:211] offset:16384
    ds_write_b128 v240, v[212:215] offset:17408
    ds_write_b128 v240, v[216:219] offset:18432
    ds_write_b128 v240, v[220:223] offset:19456
    ds_write_b128 v240, v[224:227] offset:20480
    ds_write_b128 v240, v[228:231] offset:21504
    ds_write_b128 v240, v[232:235] offset:22528
    ds_write_b128 v240, v[236:239] offset:23552
    s_mov_b32 s99, 0
    s_branch L_rv1
L_rv0:
    s_add_u32 s76, s74, 16384
    s_mov_b32 m0, s76
    s_mov_b32 s77, s78
    buffer_load_dwordx4 v16, s[36:39], s77 offen offset:0 nt lds
    buffer_load_dwordx4 v17, s[36:39], s77 offen offset:1024 nt lds
    buffer_load_dwordx4 v16, s[36:39], s77 offen offset:2048 nt lds
    buffer_load_dwordx4 v17, s[36:39], s77 offen offset:3072 nt lds
    s_add_u32 s76, s74, 20480
    s_mov_b32 m0, s76
    s_add_u32 s77, s78, 16384
    buffer_load_dwordx4 v16, s[36:39], s77 offen offset:0 nt lds
    buffer_load_dwordx4 v17, s[36:39], s77 offen offset:1024 nt lds
    buffer_load_dwordx4 v16, s[36:39], s77 offen offset:2048 nt lds
    buffer_load_dwordx4 v17, s[36:39], s77 offen offset:3072 nt lds
L_rv1:
    v_mfma_f32_16x16x32_bf16 v[144:147], v[84:87], v[124:127], v[144:147]
    v_mfma_f32_16x16x32_bf16 v[148:151], v[88:91], v[124:127], v[148:151]
    v_mfma_f32_16x16x32_bf16 v[152:155], v[92:95], v[124:127], v[152:155]
    v_mfma_f32_16x16x32_bf16 v[156:159], v[96:99], v[124:127], v[156:159]
    v_mfma_f32_16x16x32_bf16 v[160:163], v[100:103], v[124:127], v[160:163]
    v_mfma_f32_16x16x32_bf16 v[164:167], v[104:107], v[124:127], v[164:167]
    v_mfma_f32_16x16x32_bf16 v[168:171], v[108:111], v[124:127], v[168:171]
    v_mfma_f32_16x16x32_bf16 v[172:175], v[112:115], v[124:127], v[172:175]
    s_cmp_ge_u32 s79, 0x200000
    s_cbranch_scc1 L_loop_done
    s_waitcnt vmcnt(24)
    ds_read_b128 v[52:55], v24 offset:8192
    ds_read_b128 v[56:59], v25 offset:8192
    ds_read_b128 v[60:63], v26 offset:8192
    ds_read_b128 v[64:67], v27 offset:8192
    ds_read_b128 v[68:71], v24 offset:12288
    ds_read_b128 v[72:75], v25 offset:12288
    ds_read_b128 v[76:79], v26 offset:12288
    ds_read_b128 v[80:83], v27 offset:12288
    ds_write_b32 v19, v20
    s_mov_b32 s90, 0
L_qq1:
    ds_read_b32 v21, v18
    s_waitcnt lgkmcnt(0)
    v_readfirstlane_b32 s75, v21
    s_add_u32 s90, s90, 1
    s_cmp_lt_u32 s90, 0x1000000
    s_cselect_b32 s75, s75, 64
    s_cmp_eq_u32 s75, -1
    s_cbranch_scc1 L_qq1
    v_add_u32 v18, 4, v18
    v_add_u32 v20, 1, v20
    s_lshl_b32 s75, s75, 15
    s_add_u32 s79, s75, s97
    s_add_u32 s76, s74, 8192
    s_mov_b32 m0, s76
    s_mov_b32 s77, s79
    buffer_load_dwordx4 v12, s[32:35], s77 offen offset:0 nt lds
    buffer_load_dwordx4 v13, s[32:35], s77 offen offset:1024 nt lds
    buffer_load_dwordx4 v14, s[32:35], s77 offen offset:2048 nt lds
    buffer_load_dwordx4 v15, s[32:35], s77 offen offset:3072 nt lds
    s_add_u32 s76, s74, 12288
    s_mov_b32 m0, s76
    s_add_u32 s77, s79, 16384
    buffer_load_dwordx4 v12, s[32:35], s77 offen offset:0 nt lds
    buffer_load_dwordx4 v13, s[32:35], s77 offen offset:1024 nt lds
    buffer_load_dwordx4 v14, s[32:35], s77 offen offset:2048 nt lds
    buffer_load_dwordx4 v15, s[32:35], s77 offen offset:3072 nt lds
    v_mfma_f32_16x16x32_bf16 v[116:119], v[52:55], v[36:39], 0
    v_mfma_f32_16x16x32_bf16 v[120:123], v[68:71], v[36:39], 0
    v_mfma_f32_16x16x32_bf16 v[116:119], v[56:59], v[40:43], v[116:119]
    v_mfma_f32_16x16x32_bf16 v[120:123], v[72:75], v[40:43], v[120:123]
    v_mfma_f32_16x16x32_bf16 v[116:119], v[60:63], v[44:47], v[116:119]
    v_mfma_f32_16x16x32_bf16 v[120:123], v[76:79], v[44:47], v[120:123]
    v_mfma_f32_16x16x32_bf16 v[116:119], v[64:67], v[48:51], v[116:119]
    v_mfma_f32_16x16x32_bf16 v[120:123], v[80:83], v[48:51], v[120:123]
    s_nop 7
    v_cvt_pk_bf16_f32 v128, v116, v117
    v_cvt_pk_bf16_f32 v129, v118, v119
    v_cvt_pk_bf16_f32 v130, v120, v121
    v_cvt_pk_bf16_f32 v131, v122, v123
    v_lshlrev_b32 v116, 16, v128
    v_and_b32 v117, 0xffff0000, v128
    v_lshlrev_b32 v118, 16, v129
    v_and_b32 v119, 0xffff0000, v129
    v_lshlrev_b32 v120, 16, v130
    v_and_b32 v121, 0xffff0000, v130
    v_lshlrev_b32 v122, 16, v131
    v_and_b32 v123, 0xffff0000, v131
    v_mul_f32 v116, s80, v116
    v_mul_f32 v117, s80, v117
    v_mul_f32 v118, s80, v118
    v_mul_f32 v119, s80, v119
    v_mul_f32 v120, s80, v120
    v_mul_f32 v121, s80, v121
    v_mul_f32 v122, s80, v122
    v_mul_f32 v123, s80, v123
    v_cvt_pk_bf16_f32 v128, v116, v117
    v_cvt_pk_bf16_f32 v129, v118, v119
    v_cvt_pk_bf16_f32 v130, v120, v121
    v_cvt_pk_bf16_f32 v131, v122, v123
    v_lshlrev_b32 v116, 16, v128
    v_and_b32 v117, 0xffff0000, v128
    v_lshlrev_b32 v118, 16, v129
    v_and_b32 v119, 0xffff0000, v129
    v_lshlrev_b32 v120, 16, v130
    v_and_b32 v121, 0xffff0000, v130
    v_lshlrev_b32 v122, 16, v131
    v_and_b32 v123, 0xffff0000, v131
    v_max3_f32 v128, v116, v117, v118
    v_max3_f32 v129, v119, v120, v121
    v_max3_f32 v128, v128, v122, v123
    v_max_f32 v128, v128, v129
    v_cmp_gt_f32 vcc, v128, v138
    s_cbranch_vccnz L_rare1
L_back1:
    v_fma_f32 v116, v116, s81, v137
    v_fma_f32 v117, v117, s81, v137
    v_fma_f32 v118, v118, s81, v137
    v_fma_f32 v119, v119, s81, v137
    v_fma_f32 v120, v120, s81, v137
    v_fma_f32 v121, v121, s81, v137
    v_fma_f32 v122, v122, s81, v137
    v_fma_f32 v123, v123, s81, v137
    v_exp_f32 v116, v116
    v_exp_f32 v117, v117
    v_exp_f32 v118, v118
    v_exp_f32 v119, v119
    v_exp_f32 v120, v120
    v_exp_f32 v121, v121
    v_exp_f32 v122, v122
    v_exp_f32 v123, v123
    s_nop 0
    v_cvt_pk_bf16_f32 v124, v116, v117
    v_cvt_pk_bf16_f32 v125, v118, v119
    v_cvt_pk_bf16_f32 v126, v120, v121
    v_cvt_pk_bf16_f32 v127, v122, v123
    v_add_f32 v128, v116, v117
    v_add_f32 v129, v118, v119
    v_add_f32 v130, v120, v121
    v_add_f32 v131, v122, v123
    v_add_f32 v128, v128, v129
    v_add_f32 v130, v130, v131
    v_add_f32 v128, v128, v130
    v_add_f32 v139, v139, v128
    s_waitcnt vmcnt(24)
    ds_read_b64_tr_b16 v[84:85], v28 offset:8192
    ds_read_b64_tr_b16 v[86:87], v28 offset:12288
    ds_read_b64_tr_b16 v[88:89], v29 offset:8192
    ds_read_b64_tr_b16 v[90:91], v29 offset:12288
    ds_read_b64_tr_b16 v[92:93], v30 offset:8192
    ds_read_b64_tr_b16 v[94:95], v30 offset:12288
    ds_read_b64_tr_b16 v[96:97], v31 offset:8192
    ds_read_b64_tr_b16 v[98:99], v31 offset:12288
    ds_read_b64_tr_b16 v[100:101], v32 offset:8192
    ds_read_b64_tr_b16 v[102:103], v32 offset:12288
    ds_read_b64_tr_b16 v[104:105], v33 offset:8192
    ds_read_b64_tr_b16 v[106:107], v33 offset:12288
    ds_read_b64_tr_b16 v[108:109], v34 offset:8192
    ds_read_b64_tr_b16 v[110:111], v34 offset:12288
    ds_read_b64_tr_b16 v[112:113], v35 offset:8192
    ds_read_b64_tr_b16 v[114:115], v35 offset:12288
    s_waitcnt lgkmcnt(0)
    s_add_u32 s76, s74, 24576
    s_mov_b32 m0, s76
    s_mov_b32 s77, s79
    buffer_load_dwordx4 v16, s[36:39], s77 offen offset:0 nt lds
    buffer_load_dwordx4 v17, s[36:39], s77 offen offset:1024 nt lds
    buffer_load_dwordx4 v16, s[36:39], s77 offen offset:2048 nt lds
    buffer_load_dwordx4 v17, s[36:39], s77 offen offset:3072 nt lds
    s_add_u32 s76, s74, 28672
    s_mov_b32 m0, s76
    s_add_u32 s77, s79, 16384
    buffer_load_dwordx4 v16, s[36:39], s77 offen offset:0 nt lds
    buffer_load_dwordx4 v17, s[36:39], s77 offen offset:1024 nt lds
    buffer_load_dwordx4 v16, s[36:39], s77 offen offset:2048 nt lds
    buffer_load_dwordx4 v17, s[36:39], s77 offen offset:3072 nt lds
    v_mfma_f32_16x16x32_bf16 v[144:147], v[84:87], v[124:127], v[144:147]
    v_mfma_f32_16x16x32_bf16 v[148:151], v[88:91], v[124:127], v[148:151]
    v_mfma_f32_16x16x32_bf16 v[152:155], v[92:95], v[124:127], v[152:155]
    v_mfma_f32_16x16x32_bf16 v[156:159], v[96:99], v[124:127], v[156:159]
    v_mfma_f32_16x16x32_bf16 v[160:163], v[100:103], v[124:127], v[160:163]
    v_mfma_f32_16x16x32_bf16 v[164:167], v[104:107], v[124:127], v[164:167]
    v_mfma_f32_16x16x32_bf16 v[168:171], v[108:111], v[124:127], v[168:171]
    v_mfma_f32_16x16x32_bf16 v[172:175], v[112:115], v[124:127], v[172:175]
    s_cmp_ge_u32 s78, 0x200000
    s_cbranch_scc0 L_loop
L_loop_done:
    s_nop 7
    s_nop 7
    s_lshl_b32 s75, s3, 11
    s_add_u32 s75, s75, 131072
    v_lshlrev_b32 v40, 9, v22
    v_lshl_add_u32 v40, v3, 4, v40
    v_add_u32 v40, s75, v40
    s_lshl_b32 s76, s3, 2
    v_lshlrev_b32 v41, 4, v22
    v_add_u32 v41, s76, v41
    v_lshlrev_b32 v42, 2, v41
    v_lshl_add_u32 v42, v3, 2, v42
    v_add_u32 v41, 156672, v41
    v_add_u32 v42, 156736, v42
    v_cmp_gt_u32 vcc, 4, v22
    s_and_saveexec_b64 s[82:83], vcc
    ds_write_b128 v40, v[144:147] offset:0
    ds_write_b128 v40, v[148:151] offset:64
    ds_write_b128 v40, v[152:155] offset:128
    ds_write_b128 v40, v[156:159] offset:192
    ds_write_b128 v40, v[160:163] offset:256
    ds_write_b128 v40, v[164:167] offset:320
    ds_write_b128 v40, v[168:171] offset:384
    ds_write_b128 v40, v[172:175] offset:448
    ds_write_b32 v41, v136
    ds_write_b32 v42, v139
    s_mov_b64 exec, s[82:83]
    s_branch L_b3
L_sched:
    v_mov_b32 v5, 157184
    s_mov_b32 s90, 0
L_sq:
    ds_read_b32 v6, v5
    s_waitcnt lgkmcnt(0)
    v_readfirstlane_b32 s75, v6
    s_cmp_lg_u32 s75, 0
    s_cbranch_scc1 L_sq_ok
    s_add_u32 s90, s90, 1
    s_cmp_ge_u32 s90, 8000000
    s_cbranch_scc1 L_sq_ok
    s_sleep 2
    s_branch L_sq
L_sq_ok:
    s_mov_b32 s4, 8
    s_mov_b32 s5, 0
    v_mov_b32 v5, 157200
    s_mov_b64 exec, 1
L_sloop0:
    ds_read_b128 v[8:11], v5
    s_waitcnt lgkmcnt(0)
    v_max_u32 v8, v8, v9
    v_max3_u32 v8, v8, v10, v11
    s_nop 0
    v_readfirstlane_b32 s6, v8
    s_add_u32 s6, s6, 4
    s_cmp_lt_u32 s4, s6
    s_cbranch_scc1 L_sclaim
    s_sleep 2
    s_branch L_sloop0
L_sclaim:
    s_add_u32 s7, s73, s5
    s_and_b32 s7, s7, 3
    s_lshl_b32 s8, s72, 8
    s_lshl_b32 s9, s7, 6
    s_add_u32 s8, s8, s9
    s_add_u32 s8, s8, 983040
    v_mov_b32 v12, s8
    s_cmp_eq_u32 s5, 0
    s_cselect_b32 s9, 1, 0x10000
    v_mov_b32 v13, s9
    global_atomic_add v14, v12, v13, s[28:29] sc0 sc1
    s_waitcnt vmcnt(0)
    v_readfirstlane_b32 s9, v14
    s_and_b32 s10, s9, 0xffff
    s_lshr_b32 s11, s9, 16
    s_add_u32 s9, s10, s11
    s_cmp_lt_u32 s9, 8
    s_cbranch_scc1 L_sgot
    s_add_u32 s5, s5, 1
    s_cmp_lt_u32 s5, 4
    s_cbranch_scc1 L_sclaim
    s_mov_b64 exec, 0xff
    s_lshl_b32 s8, s4, 2
    s_add_u32 s8, s8, 157248
    v_lshlrev_b32 v12, 2, v2
    v_add_u32 v12, s8, v12
    v_mov_b32 v13, 64
    ds_write_b32 v12, v13
    s_mov_b64 exec, -1
    s_branch L_b3
L_sgot:
    s_add_u32 s10, s10, 8
    s_sub_u32 s11, 15, s11
    s_cmp_eq_u32 s5, 0
    s_cselect_b32 s10, s10, s11
    s_lshl_b32 s7, s7, 4
    s_add_u32 s10, s10, s7
    s_lshl_b32 s8, s4, 2
    s_add_u32 s8, s8, 157248
    v_mov_b32 v12, s8
    v_mov_b32 v13, s10
    ds_write_b32 v12, v13
    s_add_u32 s4, s4, 1
    s_branch L_sloop0
L_table:
    s_cmp_eq_u32 s3, 6
    s_cbranch_scc1 L_sched
    v_mov_b32 v6, 0
    v_mul_u32_u24 v13, 56, v2
    buffer_load_dwordx4 v[160:163], v13, s[52:55], 0 offen
    buffer_load_dwordx4 v[164:167], v13, s[52:55], 0 offen offset:16
    buffer_load_dwordx4 v[168:171], v13, s[52:55], 0 offen offset:32
    buffer_load_dwordx2 v[172:173], v13, s[52:55], 0 offen offset:48
    buffer_load_dwordx4 v[176:179], v13, s[56:59], 0 offen
    buffer_load_dwordx4 v[180:183], v13, s[56:59], 0 offen offset:16
    buffer_load_dwordx4 v[184:187], v13, s[56:59], 0 offen offset:32
    buffer_load_dwordx2 v[188:189], v13, s[56:59], 0 offen offset:48
    buffer_load_dwordx4 v[96:99], v13, s[60:63], 0 offen
    buffer_load_dwordx4 v[100:103], v13, s[60:63], 0 offen offset:16
    buffer_load_dwordx4 v[104:107], v13, s[60:63], 0 offen offset:32
    buffer_load_dwordx2 v[108:109], v13, s[60:63], 0 offen offset:48
    v_mov_b32 v13, 0
    buffer_load_ushort v192, v13, s[64:67], 0 offen
    s_waitcnt vmcnt(0)
    s_mov_b32 s12, 0xc0135761
    s_mov_b32 s14, 0xbdd2d3e8
    s_mov_b32 s15, 0xbdd2d3e8
    v_mov_b32 v38, s12
    v_mov_b32 v39, s12
    v_and_b32 v41, 0xffff0000, v160
    v_lshlrev_b32 v40, 16, v160
    v_and_b32 v69, 0xffff0000, v176
    v_lshlrev_b32 v68, 16, v176
    v_and_b32 v43, 0xffff0000, v161
    v_lshlrev_b32 v42, 16, v161
    v_and_b32 v71, 0xffff0000, v177
    v_lshlrev_b32 v70, 16, v177
    v_and_b32 v45, 0xffff0000, v162
    v_lshlrev_b32 v44, 16, v162
    v_and_b32 v73, 0xffff0000, v178
    v_lshlrev_b32 v72, 16, v178
    v_and_b32 v47, 0xffff0000, v163
    v_lshlrev_b32 v46, 16, v163
    v_and_b32 v75, 0xffff0000, v179
    v_lshlrev_b32 v74, 16, v179
    v_and_b32 v49, 0xffff0000, v164
    v_lshlrev_b32 v48, 16, v164
    v_and_b32 v77, 0xffff0000, v180
    v_lshlrev_b32 v76, 16, v180
    v_and_b32 v51, 0xffff0000, v165
    v_lshlrev_b32 v50, 16, v165
    v_and_b32 v79, 0xffff0000, v181
    v_lshlrev_b32 v78, 16, v181
    v_and_b32 v53, 0xffff0000, v166
    v_lshlrev_b32 v52, 16, v166
    v_and_b32 v81, 0xffff0000, v182
    v_lshlrev_b32 v80, 16, v182
    v_and_b32 v55, 0xffff0000, v167
    v_lshlrev_b32 v54, 16, v167
    v_and_b32 v83, 0xffff0000, v183
    v_lshlrev_b32 v82, 16, v183
    v_and_b32 v57, 0xffff0000, v168
    v_lshlrev_b32 v56, 16, v168
    v_and_b32 v85, 0xffff0000, v184
    v_lshlrev_b32 v84, 16, v184
    v_and_b32 v59, 0xffff0000, v169
    v_lshlrev_b32 v58, 16, v169
    v_and_b32 v87, 0xffff0000, v185
    v_lshlrev_b32 v86, 16, v185
    v_and_b32 v61, 0xffff0000, v170
    v_lshlrev_b32 v60, 16, v170
    v_and_b32 v89, 0xffff0000, v186
    v_lshlrev_b32 v88, 16, v186
    v_and_b32 v63, 0xffff0000, v171
    v_lshlrev_b32 v62, 16, v171
    v_and_b32 v91, 0xffff0000, v187
    v_lshlrev_b32 v90, 16, v187
    v_and_b32 v65, 0xffff0000, v172
    v_lshlrev_b32 v64, 16, v172
    v_and_b32 v93, 0xffff0000, v188
    v_lshlrev_b32 v92, 16, v188
    v_and_b32 v67, 0xffff0000, v173
    v_lshlrev_b32 v66, 16, v173
    v_and_b32 v95, 0xffff0000, v189
    v_lshlrev_b32 v94, 16, v189
    v_lshlrev_b32 v36, 16, v192
    v_mov_b32 v34, 157188
    v_mov_b32 v35, 1
L_tloop:
    s_mov_b64 exec, 1
    ds_add_rtn_u32 v33, v34, v35
    s_mov_b64 exec, -1
    s_waitcnt lgkmcnt(0)
    v_readfirstlane_b32 s90, v33
    s_cmp_ge_u32 s90, 11
    s_cbranch_scc1 L_tdone
    s_mul_i32 s75, s90, 3
    s_lshl_b32 s20, s2, 5
    s_add_u32 s76, s75, 0
    s_add_u32 s77, s20, s76
    s_mov_b32 s22, s77
    s_and_b32 s4, s77, 4095
    s_add_u32 s4, s4, 12800
    s_lshr_b32 s5, s77, 12
    s_lshl_b32 s5, s5, 15
    s_or_b32 s77, s4, s5
    s_lshl_b32 s22, s22, 2
    s_add_u32 s22, s22, 1179648
    s_lshl_b32 s4, s77, 16
    s_mov_b32 s5, s4
    v_mov_b32 v112, 0
    v_pk_mul_f32 v[116:117], v[40:41], s[4:5]
    v_pk_mul_f32 v[122:123], v[42:43], s[4:5]
    v_pk_mul_f32 v[128:129], v[44:45], s[4:5]
    v_pk_mul_f32 v[134:135], v[46:47], s[4:5]
    v_pk_mul_f32 v[140:141], v[48:49], s[4:5]
    v_pk_mul_f32 v[146:147], v[50:51], s[4:5]
    v_pk_mul_f32 v[152:153], v[52:53], s[4:5]
    v_cvt_pk_bf16_f32 v120, v116, v117
    v_cvt_pk_bf16_f32 v126, v122, v123
    v_cvt_pk_bf16_f32 v132, v128, v129
    v_cvt_pk_bf16_f32 v138, v134, v135
    v_cvt_pk_bf16_f32 v144, v140, v141
    v_cvt_pk_bf16_f32 v150, v146, v147
    v_cvt_pk_bf16_f32 v156, v152, v153
    v_lshlrev_b32 v116, 16, v120
    v_lshlrev_b32 v122, 16, v126
    v_lshlrev_b32 v128, 16, v132
    v_lshlrev_b32 v134, 16, v138
    v_lshlrev_b32 v140, 16, v144
    v_lshlrev_b32 v146, 16, v150
    v_lshlrev_b32 v152, 16, v156
    v_and_b32 v117, 0xffff0000, v120
    v_and_b32 v123, 0xffff0000, v126
    v_and_b32 v129, 0xffff0000, v132
    v_and_b32 v135, 0xffff0000, v138
    v_and_b32 v141, 0xffff0000, v144
    v_and_b32 v147, 0xffff0000, v150
    v_and_b32 v153, 0xffff0000, v156
    v_pk_add_f32 v[116:117], v[116:117], v[68:69]
    v_pk_add_f32 v[122:123], v[122:123], v[70:71]
    v_pk_add_f32 v[128:129], v[128:129], v[72:73]
    v_pk_add_f32 v[134:135], v[134:135], v[74:75]
    v_pk_add_f32 v[140:141], v[140:141], v[76:77]
    v_pk_add_f32 v[146:147], v[146:147], v[78:79]
    v_pk_add_f32 v[152:153], v[152:153], v[80:81]
    v_cvt_pk_bf16_f32 v120, v116, v117
    v_cvt_pk_bf16_f32 v126, v122, v123
    v_cvt_pk_bf16_f32 v132, v128, v129
    v_cvt_pk_bf16_f32 v138, v134, v135
    v_cvt_pk_bf16_f32 v144, v140, v141
    v_cvt_pk_bf16_f32 v150, v146, v147
    v_cvt_pk_bf16_f32 v156, v152, v153
    v_lshlrev_b32 v116, 16, v120
    v_lshlrev_b32 v122, 16, v126
    v_lshlrev_b32 v128, 16, v132
    v_lshlrev_b32 v134, 16, v138
    v_lshlrev_b32 v140, 16, v144
    v_lshlrev_b32 v146, 16, v150
    v_lshlrev_b32 v152, 16, v156
    v_and_b32 v117, 0xffff0000, v120
    v_and_b32 v123, 0xffff0000, v126
    v_and_b32 v129, 0xffff0000, v132
    v_and_b32 v135, 0xffff0000, v138
    v_and_b32 v141, 0xffff0000, v144
    v_and_b32 v147, 0xffff0000, v150
    v_and_b32 v153, 0xffff0000, v156
    v_pk_mul_f32 v[118:119], v[116:117], v[116:117]
    v_pk_mul_f32 v[124:125], v[122:123], v[122:123]
    v_pk_mul_f32 v[130:131], v[128:129], v[128:129]
    v_pk_mul_f32 v[136:137], v[134:135], v[134:135]
    v_pk_mul_f32 v[142:143], v[140:141], v[140:141]
    v_pk_mul_f32 v[148:149], v[146:147], v[146:147]
    v_pk_mul_f32 v[154:155], v[152:153], v[152:153]
    v_pk_fma_f32 v[118:119], v[118:119], s[14:15], v[38:39]
    v_pk_fma_f32 v[124:125], v[124:125], s[14:15], v[38:39]
    v_pk_fma_f32 v[130:131], v[130:131], s[14:15], v[38:39]
    v_pk_fma_f32 v[136:137], v[136:137], s[14:15], v[38:39]
    v_pk_fma_f32 v[142:143], v[142:143], s[14:15], v[38:39]
    v_pk_fma_f32 v[148:149], v[148:149], s[14:15], v[38:39]
    v_pk_fma_f32 v[154:155], v[154:155], s[14:15], v[38:39]
    v_pk_mul_f32 v[118:119], v[118:119], v[116:117]
    v_pk_mul_f32 v[124:125], v[124:125], v[122:123]
    v_pk_mul_f32 v[130:131], v[130:131], v[128:129]
    v_pk_mul_f32 v[136:137], v[136:137], v[134:135]
    v_pk_mul_f32 v[142:143], v[142:143], v[140:141]
    v_pk_mul_f32 v[148:149], v[148:149], v[146:147]
    v_pk_mul_f32 v[154:155], v[154:155], v[152:153]
    v_exp_f32 v118, v118
    v_exp_f32 v124, v124
    v_exp_f32 v130, v130
    v_exp_f32 v136, v136
    v_exp_f32 v142, v142
    v_exp_f32 v148, v148
    v_exp_f32 v154, v154
    v_exp_f32 v119, v119
    v_exp_f32 v125, v125
    v_exp_f32 v131, v131
    v_exp_f32 v137, v137
    v_exp_f32 v143, v143
    v_exp_f32 v149, v149
    v_exp_f32 v155, v155
    v_pk_add_f32 v[118:119], v[118:119], 1.0 op_sel_hi:[1,0]
    v_pk_add_f32 v[124:125], v[124:125], 1.0 op_sel_hi:[1,0]
    v_pk_add_f32 v[130:131], v[130:131], 1.0 op_sel_hi:[1,0]
    v_pk_add_f32 v[136:137], v[136:137], 1.0 op_sel_hi:[1,0]
    v_pk_add_f32 v[142:143], v[142:143], 1.0 op_sel_hi:[1,0]
    v_pk_add_f32 v[148:149], v[148:149], 1.0 op_sel_hi:[1,0]
    v_pk_add_f32 v[154:155], v[154:155], 1.0 op_sel_hi:[1,0]
    v_rcp_f32 v118, v118
    v_rcp_f32 v124, v124
    v_rcp_f32 v130, v130
    v_rcp_f32 v136, v136
    v_rcp_f32 v142, v142
    v_rcp_f32 v148, v148
    v_rcp_f32 v154, v154
    v_rcp_f32 v119, v119
    v_rcp_f32 v125, v125
    v_rcp_f32 v131, v131
    v_rcp_f32 v137, v137
    v_rcp_f32 v143, v143
    v_rcp_f32 v149, v149
    v_rcp_f32 v155, v155
    v_pk_mul_f32 v[118:119], v[118:119], v[116:117]
    v_pk_mul_f32 v[124:125], v[124:125], v[122:123]
    v_pk_mul_f32 v[130:131], v[130:131], v[128:129]
    v_pk_mul_f32 v[136:137], v[136:137], v[134:135]
    v_pk_mul_f32 v[142:143], v[142:143], v[140:141]
    v_pk_mul_f32 v[148:149], v[148:149], v[146:147]
    v_pk_mul_f32 v[154:155], v[154:155], v[152:153]
    v_cvt_pk_bf16_f32 v120, v118, v119
    v_cvt_pk_bf16_f32 v126, v124, v125
    v_cvt_pk_bf16_f32 v132, v130, v131
    v_cvt_pk_bf16_f32 v138, v136, v137
    v_cvt_pk_bf16_f32 v144, v142, v143
    v_cvt_pk_bf16_f32 v150, v148, v149
    v_cvt_pk_bf16_f32 v156, v154, v155
    v_dot2_f32_bf16 v112, v120, v96, v112
    v_dot2_f32_bf16 v112, v126, v97, v112
    v_dot2_f32_bf16 v112, v132, v98, v112
    v_dot2_f32_bf16 v112, v138, v99, v112
    v_dot2_f32_bf16 v112, v144, v100, v112
    v_dot2_f32_bf16 v112, v150, v101, v112
    v_dot2_f32_bf16 v112, v156, v102, v112
    v_pk_mul_f32 v[116:117], v[54:55], s[4:5]
    v_pk_mul_f32 v[122:123], v[56:57], s[4:5]
    v_pk_mul_f32 v[128:129], v[58:59], s[4:5]
    v_pk_mul_f32 v[134:135], v[60:61], s[4:5]
    v_pk_mul_f32 v[140:141], v[62:63], s[4:5]
    v_pk_mul_f32 v[146:147], v[64:65], s[4:5]
    v_pk_mul_f32 v[152:153], v[66:67], s[4:5]
    v_cvt_pk_bf16_f32 v120, v116, v117
    v_cvt_pk_bf16_f32 v126, v122, v123
    v_cvt_pk_bf16_f32 v132, v128, v129
    v_cvt_pk_bf16_f32 v138, v134, v135
    v_cvt_pk_bf16_f32 v144, v140, v141
    v_cvt_pk_bf16_f32 v150, v146, v147
    v_cvt_pk_bf16_f32 v156, v152, v153
    v_lshlrev_b32 v116, 16, v120
    v_lshlrev_b32 v122, 16, v126
    v_lshlrev_b32 v128, 16, v132
    v_lshlrev_b32 v134, 16, v138
    v_lshlrev_b32 v140, 16, v144
    v_lshlrev_b32 v146, 16, v150
    v_lshlrev_b32 v152, 16, v156
    v_and_b32 v117, 0xffff0000, v120
    v_and_b32 v123, 0xffff0000, v126
    v_and_b32 v129, 0xffff0000, v132
    v_and_b32 v135, 0xffff0000, v138
    v_and_b32 v141, 0xffff0000, v144
    v_and_b32 v147, 0xffff0000, v150
    v_and_b32 v153, 0xffff0000, v156
    v_pk_add_f32 v[116:117], v[116:117], v[82:83]
    v_pk_add_f32 v[122:123], v[122:123], v[84:85]
    v_pk_add_f32 v[128:129], v[128:129], v[86:87]
    v_pk_add_f32 v[134:135], v[134:135], v[88:89]
    v_pk_add_f32 v[140:141], v[140:141], v[90:91]
    v_pk_add_f32 v[146:147], v[146:147], v[92:93]
    v_pk_add_f32 v[152:153], v[152:153], v[94:95]
    v_cvt_pk_bf16_f32 v120, v116, v117
    v_cvt_pk_bf16_f32 v126, v122, v123
    v_cvt_pk_bf16_f32 v132, v128, v129
    v_cvt_pk_bf16_f32 v138, v134, v135
    v_cvt_pk_bf16_f32 v144, v140, v141
    v_cvt_pk_bf16_f32 v150, v146, v147
    v_cvt_pk_bf16_f32 v156, v152, v153
    v_lshlrev_b32 v116, 16, v120
    v_lshlrev_b32 v122, 16, v126
    v_lshlrev_b32 v128, 16, v132
    v_lshlrev_b32 v134, 16, v138
    v_lshlrev_b32 v140, 16, v144
    v_lshlrev_b32 v146, 16, v150
    v_lshlrev_b32 v152, 16, v156
    v_and_b32 v117, 0xffff0000, v120
    v_and_b32 v123, 0xffff0000, v126
    v_and_b32 v129, 0xffff0000, v132
    v_and_b32 v135, 0xffff0000, v138
    v_and_b32 v141, 0xffff0000, v144
    v_and_b32 v147, 0xffff0000, v150
    v_and_b32 v153, 0xffff0000, v156
    v_pk_mul_f32 v[118:119], v[116:117], v[116:117]
    v_pk_mul_f32 v[124:125], v[122:123], v[122:123]
    v_pk_mul_f32 v[130:131], v[128:129], v[128:129]
    v_pk_mul_f32 v[136:137], v[134:135], v[134:135]
    v_pk_mul_f32 v[142:143], v[140:141], v[140:141]
    v_pk_mul_f32 v[148:149], v[146:147], v[146:147]
    v_pk_mul_f32 v[154:155], v[152:153], v[152:153]
    v_pk_fma_f32 v[118:119], v[118:119], s[14:15], v[38:39]
    v_pk_fma_f32 v[124:125], v[124:125], s[14:15], v[38:39]
    v_pk_fma_f32 v[130:131], v[130:131], s[14:15], v[38:39]
    v_pk_fma_f32 v[136:137], v[136:137], s[14:15], v[38:39]
    v_pk_fma_f32 v[142:143], v[142:143], s[14:15], v[38:39]
    v_pk_fma_f32 v[148:149], v[148:149], s[14:15], v[38:39]
    v_pk_fma_f32 v[154:155], v[154:155], s[14:15], v[38:39]
    v_pk_mul_f32 v[118:119], v[118:119], v[116:117]
    v_pk_mul_f32 v[124:125], v[124:125], v[122:123]
    v_pk_mul_f32 v[130:131], v[130:131], v[128:129]
    v_pk_mul_f32 v[136:137], v[136:137], v[134:135]
    v_pk_mul_f32 v[142:143], v[142:143], v[140:141]
    v_pk_mul_f32 v[148:149], v[148:149], v[146:147]
    v_pk_mul_f32 v[154:155], v[154:155], v[152:153]
    v_exp_f32 v118, v118
    v_exp_f32 v124, v124
    v_exp_f32 v130, v130
    v_exp_f32 v136, v136
    v_exp_f32 v142, v142
    v_exp_f32 v148, v148
    v_exp_f32 v154, v154
    v_exp_f32 v119, v119
    v_exp_f32 v125, v125
    v_exp_f32 v131, v131
    v_exp_f32 v137, v137
    v_exp_f32 v143, v143
    v_exp_f32 v149, v149
    v_exp_f32 v155, v155
    v_pk_add_f32 v[118:119], v[118:119], 1.0 op_sel_hi:[1,0]
    v_pk_add_f32 v[124:125], v[124:125], 1.0 op_sel_hi:[1,0]
    v_pk_add_f32 v[130:131], v[130:131], 1.0 op_sel_hi:[1,0]
    v_pk_add_f32 v[136:137], v[136:137], 1.0 op_sel_hi:[1,0]
    v_pk_add_f32 v[142:143], v[142:143], 1.0 op_sel_hi:[1,0]
    v_pk_add_f32 v[148:149], v[148:149], 1.0 op_sel_hi:[1,0]
    v_pk_add_f32 v[154:155], v[154:155], 1.0 op_sel_hi:[1,0]
    v_rcp_f32 v118, v118
    v_rcp_f32 v124, v124
    v_rcp_f32 v130, v130
    v_rcp_f32 v136, v136
    v_rcp_f32 v142, v142
    v_rcp_f32 v148, v148
    v_rcp_f32 v154, v154
    v_rcp_f32 v119, v119
    v_rcp_f32 v125, v125
    v_rcp_f32 v131, v131
    v_rcp_f32 v137, v137
    v_rcp_f32 v143, v143
    v_rcp_f32 v149, v149
    v_rcp_f32 v155, v155
    v_pk_mul_f32 v[118:119], v[118:119], v[116:117]
    v_pk_mul_f32 v[124:125], v[124:125], v[122:123]
    v_pk_mul_f32 v[130:131], v[130:131], v[128:129]
    v_pk_mul_f32 v[136:137], v[136:137], v[134:135]
    v_pk_mul_f32 v[142:143], v[142:143], v[140:141]
    v_pk_mul_f32 v[148:149], v[148:149], v[146:147]
    v_pk_mul_f32 v[154:155], v[154:155], v[152:153]
    v_cvt_pk_bf16_f32 v120, v118, v119
    v_cvt_pk_bf16_f32 v126, v124, v125
    v_cvt_pk_bf16_f32 v132, v130, v131
    v_cvt_pk_bf16_f32 v138, v136, v137
    v_cvt_pk_bf16_f32 v144, v142, v143
    v_cvt_pk_bf16_f32 v150, v148, v149
    v_cvt_pk_bf16_f32 v156, v154, v155
    v_dot2_f32_bf16 v112, v120, v103, v112
    v_dot2_f32_bf16 v112, v126, v104, v112
    v_dot2_f32_bf16 v112, v132, v105, v112
    v_dot2_f32_bf16 v112, v138, v106, v112
    v_dot2_f32_bf16 v112, v144, v107, v112
    v_dot2_f32_bf16 v112, v150, v108, v112
    v_dot2_f32_bf16 v112, v156, v109, v112
    s_add_u32 s76, s75, 1
    s_add_u32 s77, s20, s76
    s_mov_b32 s23, s77
    s_and_b32 s4, s77, 4095
    s_add_u32 s4, s4, 12800
    s_lshr_b32 s5, s77, 12
    s_lshl_b32 s5, s5, 15
    s_or_b32 s77, s4, s5
    s_lshl_b32 s23, s23, 2
    s_add_u32 s23, s23, 1179648
    s_lshl_b32 s4, s77, 16
    s_mov_b32 s5, s4
    v_mov_b32 v113, 0
    v_pk_mul_f32 v[116:117], v[40:41], s[4:5]
    v_pk_mul_f32 v[122:123], v[42:43], s[4:5]
    v_pk_mul_f32 v[128:129], v[44:45], s[4:5]
    v_pk_mul_f32 v[134:135], v[46:47], s[4:5]
    v_pk_mul_f32 v[140:141], v[48:49], s[4:5]
    v_pk_mul_f32 v[146:147], v[50:51], s[4:5]
    v_pk_mul_f32 v[152:153], v[52:53], s[4:5]
    v_cvt_pk_bf16_f32 v120, v116, v117
    v_cvt_pk_bf16_f32 v126, v122, v123
    v_cvt_pk_bf16_f32 v132, v128, v129
    v_cvt_pk_bf16_f32 v138, v134, v135
    v_cvt_pk_bf16_f32 v144, v140, v141
    v_cvt_pk_bf16_f32 v150, v146, v147
    v_cvt_pk_bf16_f32 v156, v152, v153
    v_lshlrev_b32 v116, 16, v120
    v_lshlrev_b32 v122, 16, v126
    v_lshlrev_b32 v128, 16, v132
    v_lshlrev_b32 v134, 16, v138
    v_lshlrev_b32 v140, 16, v144
    v_lshlrev_b32 v146, 16, v150
    v_lshlrev_b32 v152, 16, v156
    v_and_b32 v117, 0xffff0000, v120
    v_and_b32 v123, 0xffff0000, v126
    v_and_b32 v129, 0xffff0000, v132
    v_and_b32 v135, 0xffff0000, v138
    v_and_b32 v141, 0xffff0000, v144
    v_and_b32 v147, 0xffff0000, v150
    v_and_b32 v153, 0xffff0000, v156
    v_pk_add_f32 v[116:117], v[116:117], v[68:69]
    v_pk_add_f32 v[122:123], v[122:123], v[70:71]
    v_pk_add_f32 v[128:129], v[128:129], v[72:73]
    v_pk_add_f32 v[134:135], v[134:135], v[74:75]
    v_pk_add_f32 v[140:141], v[140:141], v[76:77]
    v_pk_add_f32 v[146:147], v[146:147], v[78:79]
    v_pk_add_f32 v[152:153], v[152:153], v[80:81]
    v_cvt_pk_bf16_f32 v120, v116, v117
    v_cvt_pk_bf16_f32 v126, v122, v123
    v_cvt_pk_bf16_f32 v132, v128, v129
    v_cvt_pk_bf16_f32 v138, v134, v135
    v_cvt_pk_bf16_f32 v144, v140, v141
    v_cvt_pk_bf16_f32 v150, v146, v147
    v_cvt_pk_bf16_f32 v156, v152, v153
    v_lshlrev_b32 v116, 16, v120
    v_lshlrev_b32 v122, 16, v126
    v_lshlrev_b32 v128, 16, v132
    v_lshlrev_b32 v134, 16, v138
    v_lshlrev_b32 v140, 16, v144
    v_lshlrev_b32 v146, 16, v150
    v_lshlrev_b32 v152, 16, v156
    v_and_b32 v117, 0xffff0000, v120
    v_and_b32 v123, 0xffff0000, v126
    v_and_b32 v129, 0xffff0000, v132
    v_and_b32 v135, 0xffff0000, v138
    v_and_b32 v141, 0xffff0000, v144
    v_and_b32 v147, 0xffff0000, v150
    v_and_b32 v153, 0xffff0000, v156
    v_pk_mul_f32 v[118:119], v[116:117], v[116:117]
    v_pk_mul_f32 v[124:125], v[122:123], v[122:123]
    v_pk_mul_f32 v[130:131], v[128:129], v[128:129]
    v_pk_mul_f32 v[136:137], v[134:135], v[134:135]
    v_pk_mul_f32 v[142:143], v[140:141], v[140:141]
    v_pk_mul_f32 v[148:149], v[146:147], v[146:147]
    v_pk_mul_f32 v[154:155], v[152:153], v[152:153]
    v_pk_fma_f32 v[118:119], v[118:119], s[14:15], v[38:39]
    v_pk_fma_f32 v[124:125], v[124:125], s[14:15], v[38:39]
    v_pk_fma_f32 v[130:131], v[130:131], s[14:15], v[38:39]
    v_pk_fma_f32 v[136:137], v[136:137], s[14:15], v[38:39]
    v_pk_fma_f32 v[142:143], v[142:143], s[14:15], v[38:39]
    v_pk_fma_f32 v[148:149], v[148:149], s[14:15], v[38:39]
    v_pk_fma_f32 v[154:155], v[154:155], s[14:15], v[38:39]
    v_pk_mul_f32 v[118:119], v[118:119], v[116:117]
    v_pk_mul_f32 v[124:125], v[124:125], v[122:123]
    v_pk_mul_f32 v[130:131], v[130:131], v[128:129]
    v_pk_mul_f32 v[136:137], v[136:137], v[134:135]
    v_pk_mul_f32 v[142:143], v[142:143], v[140:141]
    v_pk_mul_f32 v[148:149], v[148:149], v[146:147]
    v_pk_mul_f32 v[154:155], v[154:155], v[152:153]
    v_exp_f32 v118, v118
    v_exp_f32 v124, v124
    v_exp_f32 v130, v130
    v_exp_f32 v136, v136
    v_exp_f32 v142, v142
    v_exp_f32 v148, v148
    v_exp_f32 v154, v154
    v_exp_f32 v119, v119
    v_exp_f32 v125, v125
    v_exp_f32 v131, v131
    v_exp_f32 v137, v137
    v_exp_f32 v143, v143
    v_exp_f32 v149, v149
    v_exp_f32 v155, v155
    v_pk_add_f32 v[118:119], v[118:119], 1.0 op_sel_hi:[1,0]
    v_pk_add_f32 v[124:125], v[124:125], 1.0 op_sel_hi:[1,0]
    v_pk_add_f32 v[130:131], v[130:131], 1.0 op_sel_hi:[1,0]
    v_pk_add_f32 v[136:137], v[136:137], 1.0 op_sel_hi:[1,0]
    v_pk_add_f32 v[142:143], v[142:143], 1.0 op_sel_hi:[1,0]
    v_pk_add_f32 v[148:149], v[148:149], 1.0 op_sel_hi:[1,0]
    v_pk_add_f32 v[154:155], v[154:155], 1.0 op_sel_hi:[1,0]
    v_rcp_f32 v118, v118
    v_rcp_f32 v124, v124
    v_rcp_f32 v130, v130
    v_rcp_f32 v136, v136
    v_rcp_f32 v142, v142
    v_rcp_f32 v148, v148
    v_rcp_f32 v154, v154
    v_rcp_f32 v119, v119
    v_rcp_f32 v125, v125
    v_rcp_f32 v131, v131
    v_rcp_f32 v137, v137
    v_rcp_f32 v143, v143
    v_rcp_f32 v149, v149
    v_rcp_f32 v155, v155
    v_pk_mul_f32 v[118:119], v[118:119], v[116:117]
    v_pk_mul_f32 v[124:125], v[124:125], v[122:123]
    v_pk_mul_f32 v[130:131], v[130:131], v[128:129]
    v_pk_mul_f32 v[136:137], v[136:137], v[134:135]
    v_pk_mul_f32 v[142:143], v[142:143], v[140:141]
    v_pk_mul_f32 v[148:149], v[148:149], v[146:147]
    v_pk_mul_f32 v[154:155], v[154:155], v[152:153]
    v_cvt_pk_bf16_f32 v120, v118, v119
    v_cvt_pk_bf16_f32 v126, v124, v125
    v_cvt_pk_bf16_f32 v132, v130, v131
    v_cvt_pk_bf16_f32 v138, v136, v137
    v_cvt_pk_bf16_f32 v144, v142, v143
    v_cvt_pk_bf16_f32 v150, v148, v149
    v_cvt_pk_bf16_f32 v156, v154, v155
    v_dot2_f32_bf16 v113, v120, v96, v113
    v_dot2_f32_bf16 v113, v126, v97, v113
    v_dot2_f32_bf16 v113, v132, v98, v113
    v_dot2_f32_bf16 v113, v138, v99, v113
    v_dot2_f32_bf16 v113, v144, v100, v113
    v_dot2_f32_bf16 v113, v150, v101, v113
    v_dot2_f32_bf16 v113, v156, v102, v113
    v_pk_mul_f32 v[116:117], v[54:55], s[4:5]
    v_pk_mul_f32 v[122:123], v[56:57], s[4:5]
    v_pk_mul_f32 v[128:129], v[58:59], s[4:5]
    v_pk_mul_f32 v[134:135], v[60:61], s[4:5]
    v_pk_mul_f32 v[140:141], v[62:63], s[4:5]
    v_pk_mul_f32 v[146:147], v[64:65], s[4:5]
    v_pk_mul_f32 v[152:153], v[66:67], s[4:5]
    v_cvt_pk_bf16_f32 v120, v116, v117
    v_cvt_pk_bf16_f32 v126, v122, v123
    v_cvt_pk_bf16_f32 v132, v128, v129
    v_cvt_pk_bf16_f32 v138, v134, v135
    v_cvt_pk_bf16_f32 v144, v140, v141
    v_cvt_pk_bf16_f32 v150, v146, v147
    v_cvt_pk_bf16_f32 v156, v152, v153
    v_lshlrev_b32 v116, 16, v120
    v_lshlrev_b32 v122, 16, v126
    v_lshlrev_b32 v128, 16, v132
    v_lshlrev_b32 v134, 16, v138
    v_lshlrev_b32 v140, 16, v144
    v_lshlrev_b32 v146, 16, v150
    v_lshlrev_b32 v152, 16, v156
    v_and_b32 v117, 0xffff0000, v120
    v_and_b32 v123, 0xffff0000, v126
    v_and_b32 v129, 0xffff0000, v132
    v_and_b32 v135, 0xffff0000, v138
    v_and_b32 v141, 0xffff0000, v144
    v_and_b32 v147, 0xffff0000, v150
    v_and_b32 v153, 0xffff0000, v156
    v_pk_add_f32 v[116:117], v[116:117], v[82:83]
    v_pk_add_f32 v[122:123], v[122:123], v[84:85]
    v_pk_add_f32 v[128:129], v[128:129], v[86:87]
    v_pk_add_f32 v[134:135], v[134:135], v[88:89]
    v_pk_add_f32 v[140:141], v[140:141], v[90:91]
    v_pk_add_f32 v[146:147], v[146:147], v[92:93]
    v_pk_add_f32 v[152:153], v[152:153], v[94:95]
    v_cvt_pk_bf16_f32 v120, v116, v117
    v_cvt_pk_bf16_f32 v126, v122, v123
    v_cvt_pk_bf16_f32 v132, v128, v129
    v_cvt_pk_bf16_f32 v138, v134, v135
    v_cvt_pk_bf16_f32 v144, v140, v141
    v_cvt_pk_bf16_f32 v150, v146, v147
    v_cvt_pk_bf16_f32 v156, v152, v153
    v_lshlrev_b32 v116, 16, v120
    v_lshlrev_b32 v122, 16, v126
    v_lshlrev_b32 v128, 16, v132
    v_lshlrev_b32 v134, 16, v138
    v_lshlrev_b32 v140, 16, v144
    v_lshlrev_b32 v146, 16, v150
    v_lshlrev_b32 v152, 16, v156
    v_and_b32 v117, 0xffff0000, v120
    v_and_b32 v123, 0xffff0000, v126
    v_and_b32 v129, 0xffff0000, v132
    v_and_b32 v135, 0xffff0000, v138
    v_and_b32 v141, 0xffff0000, v144
    v_and_b32 v147, 0xffff0000, v150
    v_and_b32 v153, 0xffff0000, v156
    v_pk_mul_f32 v[118:119], v[116:117], v[116:117]
    v_pk_mul_f32 v[124:125], v[122:123], v[122:123]
    v_pk_mul_f32 v[130:131], v[128:129], v[128:129]
    v_pk_mul_f32 v[136:137], v[134:135], v[134:135]
    v_pk_mul_f32 v[142:143], v[140:141], v[140:141]
    v_pk_mul_f32 v[148:149], v[146:147], v[146:147]
    v_pk_mul_f32 v[154:155], v[152:153], v[152:153]
    v_pk_fma_f32 v[118:119], v[118:119], s[14:15], v[38:39]
    v_pk_fma_f32 v[124:125], v[124:125], s[14:15], v[38:39]
    v_pk_fma_f32 v[130:131], v[130:131], s[14:15], v[38:39]
    v_pk_fma_f32 v[136:137], v[136:137], s[14:15], v[38:39]
    v_pk_fma_f32 v[142:143], v[142:143], s[14:15], v[38:39]
    v_pk_fma_f32 v[148:149], v[148:149], s[14:15], v[38:39]
    v_pk_fma_f32 v[154:155], v[154:155], s[14:15], v[38:39]
    v_pk_mul_f32 v[118:119], v[118:119], v[116:117]
    v_pk_mul_f32 v[124:125], v[124:125], v[122:123]
    v_pk_mul_f32 v[130:131], v[130:131], v[128:129]
    v_pk_mul_f32 v[136:137], v[136:137], v[134:135]
    v_pk_mul_f32 v[142:143], v[142:143], v[140:141]
    v_pk_mul_f32 v[148:149], v[148:149], v[146:147]
    v_pk_mul_f32 v[154:155], v[154:155], v[152:153]
    v_exp_f32 v118, v118
    v_exp_f32 v124, v124
    v_exp_f32 v130, v130
    v_exp_f32 v136, v136
    v_exp_f32 v142, v142
    v_exp_f32 v148, v148
    v_exp_f32 v154, v154
    v_exp_f32 v119, v119
    v_exp_f32 v125, v125
    v_exp_f32 v131, v131
    v_exp_f32 v137, v137
    v_exp_f32 v143, v143
    v_exp_f32 v149, v149
    v_exp_f32 v155, v155
    v_pk_add_f32 v[118:119], v[118:119], 1.0 op_sel_hi:[1,0]
    v_pk_add_f32 v[124:125], v[124:125], 1.0 op_sel_hi:[1,0]
    v_pk_add_f32 v[130:131], v[130:131], 1.0 op_sel_hi:[1,0]
    v_pk_add_f32 v[136:137], v[136:137], 1.0 op_sel_hi:[1,0]
    v_pk_add_f32 v[142:143], v[142:143], 1.0 op_sel_hi:[1,0]
    v_pk_add_f32 v[148:149], v[148:149], 1.0 op_sel_hi:[1,0]
    v_pk_add_f32 v[154:155], v[154:155], 1.0 op_sel_hi:[1,0]
    v_rcp_f32 v118, v118
    v_rcp_f32 v124, v124
    v_rcp_f32 v130, v130
    v_rcp_f32 v136, v136
    v_rcp_f32 v142, v142
    v_rcp_f32 v148, v148
    v_rcp_f32 v154, v154
    v_rcp_f32 v119, v119
    v_rcp_f32 v125, v125
    v_rcp_f32 v131, v131
    v_rcp_f32 v137, v137
    v_rcp_f32 v143, v143
    v_rcp_f32 v149, v149
    v_rcp_f32 v155, v155
    v_pk_mul_f32 v[118:119], v[118:119], v[116:117]
    v_pk_mul_f32 v[124:125], v[124:125], v[122:123]
    v_pk_mul_f32 v[130:131], v[130:131], v[128:129]
    v_pk_mul_f32 v[136:137], v[136:137], v[134:135]
    v_pk_mul_f32 v[142:143], v[142:143], v[140:141]
    v_pk_mul_f32 v[148:149], v[148:149], v[146:147]
    v_pk_mul_f32 v[154:155], v[154:155], v[152:153]
    v_cvt_pk_bf16_f32 v120, v118, v119
    v_cvt_pk_bf16_f32 v126, v124, v125
    v_cvt_pk_bf16_f32 v132, v130, v131
    v_cvt_pk_bf16_f32 v138, v136, v137
    v_cvt_pk_bf16_f32 v144, v142, v143
    v_cvt_pk_bf16_f32 v150, v148, v149
    v_cvt_pk_bf16_f32 v156, v154, v155
    v_dot2_f32_bf16 v113, v120, v103, v113
    v_dot2_f32_bf16 v113, v126, v104, v113
    v_dot2_f32_bf16 v113, v132, v105, v113
    v_dot2_f32_bf16 v113, v138, v106, v113
    v_dot2_f32_bf16 v113, v144, v107, v113
    v_dot2_f32_bf16 v113, v150, v108, v113
    v_dot2_f32_bf16 v113, v156, v109, v113
    s_add_u32 s76, s75, 2
    s_add_u32 s77, s20, s76
    s_mov_b32 s24, s77
    s_and_b32 s4, s77, 4095
    s_add_u32 s4, s4, 12800
    s_lshr_b32 s5, s77, 12
    s_lshl_b32 s5, s5, 15
    s_or_b32 s77, s4, s5
    s_add_u32 s4, s2, 8192
    s_cmp_lt_u32 s76, 32
    s_cselect_b32 s77, s77, 0
    s_cselect_b32 s24, s24, s4
    s_lshl_b32 s24, s24, 2
    s_add_u32 s24, s24, 1179648
    s_lshl_b32 s4, s77, 16
    s_mov_b32 s5, s4
    v_mov_b32 v114, 0
    v_pk_mul_f32 v[116:117], v[40:41], s[4:5]
    v_pk_mul_f32 v[122:123], v[42:43], s[4:5]
    v_pk_mul_f32 v[128:129], v[44:45], s[4:5]
    v_pk_mul_f32 v[134:135], v[46:47], s[4:5]
    v_pk_mul_f32 v[140:141], v[48:49], s[4:5]
    v_pk_mul_f32 v[146:147], v[50:51], s[4:5]
    v_pk_mul_f32 v[152:153], v[52:53], s[4:5]
    v_cvt_pk_bf16_f32 v120, v116, v117
    v_cvt_pk_bf16_f32 v126, v122, v123
    v_cvt_pk_bf16_f32 v132, v128, v129
    v_cvt_pk_bf16_f32 v138, v134, v135
    v_cvt_pk_bf16_f32 v144, v140, v141
    v_cvt_pk_bf16_f32 v150, v146, v147
    v_cvt_pk_bf16_f32 v156, v152, v153
    v_lshlrev_b32 v116, 16, v120
    v_lshlrev_b32 v122, 16, v126
    v_lshlrev_b32 v128, 16, v132
    v_lshlrev_b32 v134, 16, v138
    v_lshlrev_b32 v140, 16, v144
    v_lshlrev_b32 v146, 16, v150
    v_lshlrev_b32 v152, 16, v156
    v_and_b32 v117, 0xffff0000, v120
    v_and_b32 v123, 0xffff0000, v126
    v_and_b32 v129, 0xffff0000, v132
    v_and_b32 v135, 0xffff0000, v138
    v_and_b32 v141, 0xffff0000, v144
    v_and_b32 v147, 0xffff0000, v150
    v_and_b32 v153, 0xffff0000, v156
    v_pk_add_f32 v[116:117], v[116:117], v[68:69]
    v_pk_add_f32 v[122:123], v[122:123], v[70:71]
    v_pk_add_f32 v[128:129], v[128:129], v[72:73]
    v_pk_add_f32 v[134:135], v[134:135], v[74:75]
    v_pk_add_f32 v[140:141], v[140:141], v[76:77]
    v_pk_add_f32 v[146:147], v[146:147], v[78:79]
    v_pk_add_f32 v[152:153], v[152:153], v[80:81]
    v_cvt_pk_bf16_f32 v120, v116, v117
    v_cvt_pk_bf16_f32 v126, v122, v123
    v_cvt_pk_bf16_f32 v132, v128, v129
    v_cvt_pk_bf16_f32 v138, v134, v135
    v_cvt_pk_bf16_f32 v144, v140, v141
    v_cvt_pk_bf16_f32 v150, v146, v147
    v_cvt_pk_bf16_f32 v156, v152, v153
    v_lshlrev_b32 v116, 16, v120
    v_lshlrev_b32 v122, 16, v126
    v_lshlrev_b32 v128, 16, v132
    v_lshlrev_b32 v134, 16, v138
    v_lshlrev_b32 v140, 16, v144
    v_lshlrev_b32 v146, 16, v150
    v_lshlrev_b32 v152, 16, v156
    v_and_b32 v117, 0xffff0000, v120
    v_and_b32 v123, 0xffff0000, v126
    v_and_b32 v129, 0xffff0000, v132
    v_and_b32 v135, 0xffff0000, v138
    v_and_b32 v141, 0xffff0000, v144
    v_and_b32 v147, 0xffff0000, v150
    v_and_b32 v153, 0xffff0000, v156
    v_pk_mul_f32 v[118:119], v[116:117], v[116:117]
    v_pk_mul_f32 v[124:125], v[122:123], v[122:123]
    v_pk_mul_f32 v[130:131], v[128:129], v[128:129]
    v_pk_mul_f32 v[136:137], v[134:135], v[134:135]
    v_pk_mul_f32 v[142:143], v[140:141], v[140:141]
    v_pk_mul_f32 v[148:149], v[146:147], v[146:147]
    v_pk_mul_f32 v[154:155], v[152:153], v[152:153]
    v_pk_fma_f32 v[118:119], v[118:119], s[14:15], v[38:39]
    v_pk_fma_f32 v[124:125], v[124:125], s[14:15], v[38:39]
    v_pk_fma_f32 v[130:131], v[130:131], s[14:15], v[38:39]
    v_pk_fma_f32 v[136:137], v[136:137], s[14:15], v[38:39]
    v_pk_fma_f32 v[142:143], v[142:143], s[14:15], v[38:39]
    v_pk_fma_f32 v[148:149], v[148:149], s[14:15], v[38:39]
    v_pk_fma_f32 v[154:155], v[154:155], s[14:15], v[38:39]
    v_pk_mul_f32 v[118:119], v[118:119], v[116:117]
    v_pk_mul_f32 v[124:125], v[124:125], v[122:123]
    v_pk_mul_f32 v[130:131], v[130:131], v[128:129]
    v_pk_mul_f32 v[136:137], v[136:137], v[134:135]
    v_pk_mul_f32 v[142:143], v[142:143], v[140:141]
    v_pk_mul_f32 v[148:149], v[148:149], v[146:147]
    v_pk_mul_f32 v[154:155], v[154:155], v[152:153]
    v_exp_f32 v118, v118
    v_exp_f32 v124, v124
    v_exp_f32 v130, v130
    v_exp_f32 v136, v136
    v_exp_f32 v142, v142
    v_exp_f32 v148, v148
    v_exp_f32 v154, v154
    v_exp_f32 v119, v119
    v_exp_f32 v125, v125
    v_exp_f32 v131, v131
    v_exp_f32 v137, v137
    v_exp_f32 v143, v143
    v_exp_f32 v149, v149
    v_exp_f32 v155, v155
    v_pk_add_f32 v[118:119], v[118:119], 1.0 op_sel_hi:[1,0]
    v_pk_add_f32 v[124:125], v[124:125], 1.0 op_sel_hi:[1,0]
    v_pk_add_f32 v[130:131], v[130:131], 1.0 op_sel_hi:[1,0]
    v_pk_add_f32 v[136:137], v[136:137], 1.0 op_sel_hi:[1,0]
    v_pk_add_f32 v[142:143], v[142:143], 1.0 op_sel_hi:[1,0]
    v_pk_add_f32 v[148:149], v[148:149], 1.0 op_sel_hi:[1,0]
    v_pk_add_f32 v[154:155], v[154:155], 1.0 op_sel_hi:[1,0]
    v_rcp_f32 v118, v118
    v_rcp_f32 v124, v124
    v_rcp_f32 v130, v130
    v_rcp_f32 v136, v136
    v_rcp_f32 v142, v142
    v_rcp_f32 v148, v148
    v_rcp_f32 v154, v154
    v_rcp_f32 v119, v119
    v_rcp_f32 v125, v125
    v_rcp_f32 v131, v131
    v_rcp_f32 v137, v137
    v_rcp_f32 v143, v143
    v_rcp_f32 v149, v149
    v_rcp_f32 v155, v155
    v_pk_mul_f32 v[118:119], v[118:119], v[116:117]
    v_pk_mul_f32 v[124:125], v[124:125], v[122:123]
    v_pk_mul_f32 v[130:131], v[130:131], v[128:129]
    v_pk_mul_f32 v[136:137], v[136:137], v[134:135]
    v_pk_mul_f32 v[142:143], v[142:143], v[140:141]
    v_pk_mul_f32 v[148:149], v[148:149], v[146:147]
    v_pk_mul_f32 v[154:155], v[154:155], v[152:153]
    v_cvt_pk_bf16_f32 v120, v118, v119
    v_cvt_pk_bf16_f32 v126, v124, v125
    v_cvt_pk_bf16_f32 v132, v130, v131
    v_cvt_pk_bf16_f32 v138, v136, v137
    v_cvt_pk_bf16_f32 v144, v142, v143
    v_cvt_pk_bf16_f32 v150, v148, v149
    v_cvt_pk_bf16_f32 v156, v154, v155
    v_dot2_f32_bf16 v114, v120, v96, v114
    v_dot2_f32_bf16 v114, v126, v97, v114
    v_dot2_f32_bf16 v114, v132, v98, v114
    v_dot2_f32_bf16 v114, v138, v99, v114
    v_dot2_f32_bf16 v114, v144, v100, v114
    v_dot2_f32_bf16 v114, v150, v101, v114
    v_dot2_f32_bf16 v114, v156, v102, v114
    v_pk_mul_f32 v[116:117], v[54:55], s[4:5]
    v_pk_mul_f32 v[122:123], v[56:57], s[4:5]
    v_pk_mul_f32 v[128:129], v[58:59], s[4:5]
    v_pk_mul_f32 v[134:135], v[60:61], s[4:5]
    v_pk_mul_f32 v[140:141], v[62:63], s[4:5]
    v_pk_mul_f32 v[146:147], v[64:65], s[4:5]
    v_pk_mul_f32 v[152:153], v[66:67], s[4:5]
    v_cvt_pk_bf16_f32 v120, v116, v117
    v_cvt_pk_bf16_f32 v126, v122, v123
    v_cvt_pk_bf16_f32 v132, v128, v129
    v_cvt_pk_bf16_f32 v138, v134, v135
    v_cvt_pk_bf16_f32 v144, v140, v141
    v_cvt_pk_bf16_f32 v150, v146, v147
    v_cvt_pk_bf16_f32 v156, v152, v153
    v_lshlrev_b32 v116, 16, v120
    v_lshlrev_b32 v122, 16, v126
    v_lshlrev_b32 v128, 16, v132
    v_lshlrev_b32 v134, 16, v138
    v_lshlrev_b32 v140, 16, v144
    v_lshlrev_b32 v146, 16, v150
    v_lshlrev_b32 v152, 16, v156
    v_and_b32 v117, 0xffff0000, v120
    v_and_b32 v123, 0xffff0000, v126
    v_and_b32 v129, 0xffff0000, v132
    v_and_b32 v135, 0xffff0000, v138
    v_and_b32 v141, 0xffff0000, v144
    v_and_b32 v147, 0xffff0000, v150
    v_and_b32 v153, 0xffff0000, v156
    v_pk_add_f32 v[116:117], v[116:117], v[82:83]
    v_pk_add_f32 v[122:123], v[122:123], v[84:85]
    v_pk_add_f32 v[128:129], v[128:129], v[86:87]
    v_pk_add_f32 v[134:135], v[134:135], v[88:89]
    v_pk_add_f32 v[140:141], v[140:141], v[90:91]
    v_pk_add_f32 v[146:147], v[146:147], v[92:93]
    v_pk_add_f32 v[152:153], v[152:153], v[94:95]
    v_cvt_pk_bf16_f32 v120, v116, v117
    v_cvt_pk_bf16_f32 v126, v122, v123
    v_cvt_pk_bf16_f32 v132, v128, v129
    v_cvt_pk_bf16_f32 v138, v134, v135
    v_cvt_pk_bf16_f32 v144, v140, v141
    v_cvt_pk_bf16_f32 v150, v146, v147
    v_cvt_pk_bf16_f32 v156, v152, v153
    v_lshlrev_b32 v116, 16, v120
    v_lshlrev_b32 v122, 16, v126
    v_lshlrev_b32 v128, 16, v132
    v_lshlrev_b32 v134, 16, v138
    v_lshlrev_b32 v140, 16, v144
    v_lshlrev_b32 v146, 16, v150
    v_lshlrev_b32 v152, 16, v156
    v_and_b32 v117, 0xffff0000, v120
    v_and_b32 v123, 0xffff0000, v126
    v_and_b32 v129, 0xffff0000, v132
    v_and_b32 v135, 0xffff0000, v138
    v_and_b32 v141, 0xffff0000, v144
    v_and_b32 v147, 0xffff0000, v150
    v_and_b32 v153, 0xffff0000, v156
    v_pk_mul_f32 v[118:119], v[116:117], v[116:117]
    v_pk_mul_f32 v[124:125], v[122:123], v[122:123]
    v_pk_mul_f32 v[130:131], v[128:129], v[128:129]
    v_pk_mul_f32 v[136:137], v[134:135], v[134:135]
    v_pk_mul_f32 v[142:143], v[140:141], v[140:141]
    v_pk_mul_f32 v[148:149], v[146:147], v[146:147]
    v_pk_mul_f32 v[154:155], v[152:153], v[152:153]
    v_pk_fma_f32 v[118:119], v[118:119], s[14:15], v[38:39]
    v_pk_fma_f32 v[124:125], v[124:125], s[14:15], v[38:39]
    v_pk_fma_f32 v[130:131], v[130:131], s[14:15], v[38:39]
    v_pk_fma_f32 v[136:137], v[136:137], s[14:15], v[38:39]
    v_pk_fma_f32 v[142:143], v[142:143], s[14:15], v[38:39]
    v_pk_fma_f32 v[148:149], v[148:149], s[14:15], v[38:39]
    v_pk_fma_f32 v[154:155], v[154:155], s[14:15], v[38:39]
    v_pk_mul_f32 v[118:119], v[118:119], v[116:117]
    v_pk_mul_f32 v[124:125], v[124:125], v[122:123]
    v_pk_mul_f32 v[130:131], v[130:131], v[128:129]
    v_pk_mul_f32 v[136:137], v[136:137], v[134:135]
    v_pk_mul_f32 v[142:143], v[142:143], v[140:141]
    v_pk_mul_f32 v[148:149], v[148:149], v[146:147]
    v_pk_mul_f32 v[154:155], v[154:155], v[152:153]
    v_exp_f32 v118, v118
    v_exp_f32 v124, v124
    v_exp_f32 v130, v130
    v_exp_f32 v136, v136
    v_exp_f32 v142, v142
    v_exp_f32 v148, v148
    v_exp_f32 v154, v154
    v_exp_f32 v119, v119
    v_exp_f32 v125, v125
    v_exp_f32 v131, v131
    v_exp_f32 v137, v137
    v_exp_f32 v143, v143
    v_exp_f32 v149, v149
    v_exp_f32 v155, v155
    v_pk_add_f32 v[118:119], v[118:119], 1.0 op_sel_hi:[1,0]
    v_pk_add_f32 v[124:125], v[124:125], 1.0 op_sel_hi:[1,0]
    v_pk_add_f32 v[130:131], v[130:131], 1.0 op_sel_hi:[1,0]
    v_pk_add_f32 v[136:137], v[136:137], 1.0 op_sel_hi:[1,0]
    v_pk_add_f32 v[142:143], v[142:143], 1.0 op_sel_hi:[1,0]
    v_pk_add_f32 v[148:149], v[148:149], 1.0 op_sel_hi:[1,0]
    v_pk_add_f32 v[154:155], v[154:155], 1.0 op_sel_hi:[1,0]
    v_rcp_f32 v118, v118
    v_rcp_f32 v124, v124
    v_rcp_f32 v130, v130
    v_rcp_f32 v136, v136
    v_rcp_f32 v142, v142
    v_rcp_f32 v148, v148
    v_rcp_f32 v154, v154
    v_rcp_f32 v119, v119
    v_rcp_f32 v125, v125
    v_rcp_f32 v131, v131
    v_rcp_f32 v137, v137
    v_rcp_f32 v143, v143
    v_rcp_f32 v149, v149
    v_rcp_f32 v155, v155
    v_pk_mul_f32 v[118:119], v[118:119], v[116:117]
    v_pk_mul_f32 v[124:125], v[124:125], v[122:123]
    v_pk_mul_f32 v[130:131], v[130:131], v[128:129]
    v_pk_mul_f32 v[136:137], v[136:137], v[134:135]
    v_pk_mul_f32 v[142:143], v[142:143], v[140:141]
    v_pk_mul_f32 v[148:149], v[148:149], v[146:147]
    v_pk_mul_f32 v[154:155], v[154:155], v[152:153]
    v_cvt_pk_bf16_f32 v120, v118, v119
    v_cvt_pk_bf16_f32 v126, v124, v125
    v_cvt_pk_bf16_f32 v132, v130, v131
    v_cvt_pk_bf16_f32 v138, v136, v137
    v_cvt_pk_bf16_f32 v144, v142, v143
    v_cvt_pk_bf16_f32 v150, v148, v149
    v_cvt_pk_bf16_f32 v156, v154, v155
    v_dot2_f32_bf16 v114, v120, v103, v114
    v_dot2_f32_bf16 v114, v126, v104, v114
    v_dot2_f32_bf16 v114, v132, v105, v114
    v_dot2_f32_bf16 v114, v138, v106, v114
    v_dot2_f32_bf16 v114, v144, v107, v114
    v_dot2_f32_bf16 v114, v150, v108, v114
    v_dot2_f32_bf16 v114, v156, v109, v114
    s_nop 2
    s_nop 1
    v_add_f32_dpp v112, v112, v112 quad_perm:[1,0,3,2] row_mask:0xf bank_mask:0xf
    v_add_f32_dpp v113, v113, v113 quad_perm:[1,0,3,2] row_mask:0xf bank_mask:0xf
    v_add_f32_dpp v114, v114, v114 quad_perm:[1,0,3,2] row_mask:0xf bank_mask:0xf
    s_nop 1
    v_add_f32_dpp v112, v112, v112 quad_perm:[2,3,0,1] row_mask:0xf bank_mask:0xf
    v_add_f32_dpp v113, v113, v113 quad_perm:[2,3,0,1] row_mask:0xf bank_mask:0xf
    v_add_f32_dpp v114, v114, v114 quad_perm:[2,3,0,1] row_mask:0xf bank_mask:0xf
    s_nop 1
    v_add_f32_dpp v112, v112, v112 row_half_mirror row_mask:0xf bank_mask:0xf
    v_add_f32_dpp v113, v113, v113 row_half_mirror row_mask:0xf bank_mask:0xf
    v_add_f32_dpp v114, v114, v114 row_half_mirror row_mask:0xf bank_mask:0xf
    s_nop 1
    v_add_f32_dpp v112, v112, v112 row_mirror row_mask:0xf bank_mask:0xf
    v_add_f32_dpp v113, v113, v113 row_mirror row_mask:0xf bank_mask:0xf
    v_add_f32_dpp v114, v114, v114 row_mirror row_mask:0xf bank_mask:0xf
    s_nop 1
    v_add_f32_dpp v112, v112, v112 row_bcast:15 row_mask:0xa bank_mask:0xf
    v_add_f32_dpp v113, v113, v113 row_bcast:15 row_mask:0xa bank_mask:0xf
    v_add_f32_dpp v114, v114, v114 row_bcast:15 row_mask:0xa bank_mask:0xf
    s_nop 1
    v_add_f32_dpp v112, v112, v112 row_bcast:31 row_mask:0xc bank_mask:0xf
    v_add_f32_dpp v113, v113, v113 row_bcast:31 row_mask:0xc bank_mask:0xf
    v_add_f32_dpp v114, v114, v114 row_bcast:31 row_mask:0xc bank_mask:0xf
    v_cvt_pk_bf16_f32 v112, v112, v112
    v_lshlrev_b32 v112, 16, v112
    v_add_f32 v112, v112, v36
    v_cvt_pk_bf16_f32 v112, v112, v112
    v_lshlrev_b32 v112, 16, v112
    v_cvt_pk_bf16_f32 v113, v113, v113
    v_lshlrev_b32 v113, 16, v113
    v_add_f32 v113, v113, v36
    v_cvt_pk_bf16_f32 v113, v113, v113
    v_lshlrev_b32 v113, 16, v113
    v_cvt_pk_bf16_f32 v114, v114, v114
    v_lshlrev_b32 v114, 16, v114
    v_add_f32 v114, v114, v36
    v_cvt_pk_bf16_f32 v114, v114, v114
    v_lshlrev_b32 v114, 16, v114
    s_mov_b32 exec_lo, 0
    s_mov_b32 exec_hi, 0x80000000
    buffer_store_dword v112, v6, s[40:43], s22 offen sc1
    buffer_store_dword v113, v6, s[40:43], s23 offen sc1
    buffer_store_dword v114, v6, s[40:43], s24 offen sc1
    s_mov_b64 exec, -1
    s_branch L_tloop
L_tdone:
    s_cmp_lg_u32 s3, 5
    s_cbranch_scc1 L_nodry
    s_mov_b32 s98, 1
    s_mov_b32 s101, 0
    s_mov_b64 exec, 0
    s_branch L_tail
L_nodry:
    s_cmp_lg_u32 s3, 7
    s_cbranch_scc1 L_b3
    v_lshlrev_b32 v16, 2, v2
    s_mov_b32 s90, 0
    s_mov_b32 s91, 0x01010101
L_gpoll:
    global_load_dword v17, v16, s[26:27] sc1
    s_waitcnt vmcnt(0)
    v_cmp_ne_u32 vcc, s91, v17
    s_nop 1
    s_cmp_eq_u64 vcc, 0
    s_cbranch_scc1 L_b3
    s_add_u32 s90, s90, 1
    s_cmp_ge_u32 s90, 400000
    s_cbranch_scc1 L_b3
    s_sleep 100
    s_branch L_gpoll
L_b3:
    s_waitcnt vmcnt(0) lgkmcnt(0)
    s_barrier
L_tail:
    s_cmp_ge_u32 s101, 2
    s_cbranch_scc1 L_t2
    v_lshrrev_b32 v4, 5, v0
    v_and_b32 v5, 31, v0
    v_lshlrev_b32 v6, 4, v4
    v_add_u32 v6, 156672, v6
    ds_read_b128 v[44:47], v6
    v_lshlrev_b32 v6, 6, v4
    v_add_u32 v6, 156736, v6
    ds_read_b128 v[48:51], v6 offset:0
    ds_read_b128 v[52:55], v6 offset:16
    ds_read_b128 v[56:59], v6 offset:32
    ds_read_b128 v[60:63], v6 offset:48
    v_lshlrev_b32 v6, 9, v4
    v_lshl_add_u32 v6, v5, 4, v6
    v_add_u32 v6, 131072, v6
    ds_read_b128 v[64:67], v6 offset:0
    ds_read_b128 v[68:71], v6 offset:2048
    ds_read_b128 v[72:75], v6 offset:4096
    ds_read_b128 v[76:79], v6 offset:6144
    s_waitcnt lgkmcnt(0)
    v_max3_f32 v80, v44, v45, v46
    v_max_f32 v80, v80, v47
    v_sub_f32 v44, v44, v80
    v_mul_f32 v44, s81, v44
    v_exp_f32 v44, v44
    v_sub_f32 v45, v45, v80
    v_mul_f32 v45, s81, v45
    v_exp_f32 v45, v45
    v_sub_f32 v46, v46, v80
    v_mul_f32 v46, s81, v46
    v_exp_f32 v46, v46
    v_sub_f32 v47, v47, v80
    v_mul_f32 v47, s81, v47
    v_exp_f32 v47, v47
    v_add_f32 v48, v48, v49
    v_add_f32 v50, v50, v51
    v_add_f32 v48, v48, v50
    v_add_f32 v52, v52, v53
    v_add_f32 v54, v54, v55
    v_add_f32 v52, v52, v54
    v_add_f32 v56, v56, v57
    v_add_f32 v58, v58, v59
    v_add_f32 v56, v56, v58
    v_add_f32 v60, v60, v61
    v_add_f32 v62, v62, v63
    v_add_f32 v60, v60, v62
    v_mul_f32 v81, v44, v48
    v_mul_f32 v84, v44, v64
    v_mul_f32 v85, v44, v65
    v_mul_f32 v86, v44, v66
    v_mul_f32 v87, v44, v67
    v_fmac_f32 v81, v45, v52
    v_fmac_f32 v84, v45, v68
    v_fmac_f32 v85, v45, v69
    v_fmac_f32 v86, v45, v70
    v_fmac_f32 v87, v45, v71
    v_fmac_f32 v81, v46, v56
    v_fmac_f32 v84, v46, v72
    v_fmac_f32 v85, v46, v73
    v_fmac_f32 v86, v46, v74
    v_fmac_f32 v87, v46, v75
    v_fmac_f32 v81, v47, v60
    v_fmac_f32 v84, v47, v76
    v_fmac_f32 v85, v47, v77
    v_fmac_f32 v86, v47, v78
    v_fmac_f32 v87, v47, v79
    v_lshlrev_b32 v6, 11, v4
    v_lshl_add_u32 v6, v5, 4, v6
    s_lshl_b32 s75, s72, 13
    s_lshl_b32 s76, s73, 9
    s_add_u32 s75, s75, s76
    s_add_u32 s75, s75, 65536
    buffer_store_dwordx4 v[84:87], v6, s[40:43], s75 offen sc1
    v_lshlrev_b32 v6, 5, v4
    s_lshl_b32 s75, s72, 7
    s_lshl_b32 s76, s73, 3
    s_add_u32 s75, s75, s76
    s_add_u32 s75, s75, 589824
    v_cmp_eq_u32 vcc, 0, v5
    s_and_saveexec_b64 s[82:83], vcc
    buffer_store_dwordx2 v[80:81], v6, s[40:43], s75 offen sc1
    s_mov_b64 exec, s[82:83]
L_t2:
    v_lshrrev_b32 v4, 5, v2
    v_and_b32 v5, 31, v2
    s_lshr_b32 s75, s2, 4
    s_lshl_b32 s75, s75, 1
    s_lshl_b32 s76, s3, 5
    s_add_u32 s75, s75, s76
    v_lshlrev_b32 v6, 5, v4
    s_lshl_b32 s76, s75, 5
    s_add_u32 s76, s76, 589824
    v_lshlrev_b32 v7, 11, v4
    v_lshl_add_u32 v7, v5, 4, v7
    s_lshl_b32 s77, s75, 11
    s_add_u32 s77, s77, 65536
    s_mov_b32 s90, 0
L_mlpoll:
    buffer_load_dwordx4 v[16:19], v6, s[40:43], s76 offen sc1
    buffer_load_dwordx4 v[20:23], v6, s[40:43], s76 offen offset:16 sc1
    buffer_load_dwordx4 v[24:27], v7, s[40:43], s77 offen offset:0 sc1
    buffer_load_dwordx4 v[28:31], v7, s[40:43], s77 offen offset:512 sc1
    buffer_load_dwordx4 v[32:35], v7, s[40:43], s77 offen offset:1024 sc1
    buffer_load_dwordx4 v[36:39], v7, s[40:43], s77 offen offset:1536 sc1
    s_waitcnt vmcnt(0)
    v_max_u32 v40, v16, v17
    v_max3_u32 v40, v40, v18, v19
    v_max3_u32 v40, v40, v20, v21
    v_max3_u32 v40, v40, v22, v23
    v_max3_u32 v40, v40, v24, v25
    v_max3_u32 v40, v40, v26, v27
    v_max3_u32 v40, v40, v28, v29
    v_max3_u32 v40, v40, v30, v31
    v_max3_u32 v40, v40, v32, v33
    v_max3_u32 v40, v40, v34, v35
    v_max3_u32 v40, v40, v36, v37
    v_max3_u32 v40, v40, v38, v39
    v_cmp_eq_u32 vcc, -1, v40
    s_nop 1
    s_cmp_eq_u64 vcc, 0
    s_cbranch_scc1 L_mlready
    s_add_u32 s90, s90, 1
    s_cmp_ge_u32 s90, 400000
    s_cbranch_scc1 L_mlready
    s_sleep 1
    s_branch L_mlpoll
L_mlready:
    v_max3_f32 v60, v16, v18, v20
    v_max_f32 v60, v60, v22
    v_sub_f32 v44, v16, v60
    v_mul_f32 v44, s81, v44
    v_exp_f32 v44, v44
    v_sub_f32 v45, v18, v60
    v_mul_f32 v45, s81, v45
    v_exp_f32 v45, v45
    v_sub_f32 v46, v20, v60
    v_mul_f32 v46, s81, v46
    v_exp_f32 v46, v46
    v_sub_f32 v47, v22, v60
    v_mul_f32 v47, s81, v47
    v_exp_f32 v47, v47
    s_nop 0
    v_mul_f32 v61, v44, v17
    v_fmac_f32 v61, v45, v19
    v_fmac_f32 v61, v46, v21
    v_fmac_f32 v61, v47, v23
    v_rcp_f32 v61, v61
    s_nop 0
    v_mul_f32 v44, v44, v61
    v_mul_f32 v45, v45, v61
    v_mul_f32 v46, v46, v61
    v_mul_f32 v47, v47, v61
L_poready:
    v_mul_f32 v48, v44, v24
    v_fmac_f32 v48, v45, v28
    v_fmac_f32 v48, v46, v32
    v_fmac_f32 v48, v47, v36
    v_mul_f32 v49, v44, v25
    v_fmac_f32 v49, v45, v29
    v_fmac_f32 v49, v46, v33
    v_fmac_f32 v49, v47, v37
    v_mul_f32 v50, v44, v26
    v_fmac_f32 v50, v45, v30
    v_fmac_f32 v50, v46, v34
    v_fmac_f32 v50, v47, v38
    v_mul_f32 v51, v44, v27
    v_fmac_f32 v51, v45, v31
    v_fmac_f32 v51, v46, v35
    v_fmac_f32 v51, v47, v39
    v_cvt_pk_bf16_f32 v52, v48, v49
    v_cvt_pk_bf16_f32 v53, v50, v51
    v_lshlrev_b32 v6, 3, v0
    v_add_u32 v6, 157696, v6
    ds_write_b64 v6, v[52:53]
    s_waitcnt lgkmcnt(0)
    s_cbranch_execz L_skipB4
    s_barrier
L_skipB4:
    s_cmp_ge_u32 s101, 2
    s_cbranch_scc1 L_t4
    v_and_b32 v22, 15, v2
    v_bfe_u32 v4, v2, 2, 2
    v_and_b32 v5, 3, v2
    v_lshl_add_u32 v6, v3, 3, v4
    v_lshlrev_b32 v6, 6, v6
    v_lshl_add_u32 v6, v5, 3, v6
    s_lshl_b32 s75, s3, 5
    s_add_u32 s75, s75, 139264
    v_add_u32 v6, s75, v6
    v_and_b32 v7, 7, v2
    v_lshlrev_b32 v7, 9, v7
    v_lshl_add_u32 v7, v3, 4, v7
    v_add_u32 v7, 157696, v7
    ds_read_b64_tr_b16 v[32:33], v6 offset:0
    ds_read_b64_tr_b16 v[34:35], v6 offset:256
    ds_read_b128 v[64:67], v7 offset:0
    ds_read_b64_tr_b16 v[36:37], v6 offset:2048
    ds_read_b64_tr_b16 v[38:39], v6 offset:2304
    ds_read_b128 v[68:71], v7 offset:64
    ds_read_b64_tr_b16 v[40:41], v6 offset:4096
    ds_read_b64_tr_b16 v[42:43], v6 offset:4352
    ds_read_b128 v[72:75], v7 offset:128
    ds_read_b64_tr_b16 v[44:45], v6 offset:6144
    ds_read_b64_tr_b16 v[46:47], v6 offset:6400
    ds_read_b128 v[76:79], v7 offset:192
    s_waitcnt lgkmcnt(0)
    ds_read_b64_tr_b16 v[48:49], v6 offset:8192
    ds_read_b64_tr_b16 v[50:51], v6 offset:8448
    ds_read_b128 v[80:83], v7 offset:256
    ds_read_b64_tr_b16 v[52:53], v6 offset:10240
    ds_read_b64_tr_b16 v[54:55], v6 offset:10496
    ds_read_b128 v[84:87], v7 offset:320
    ds_read_b64_tr_b16 v[56:57], v6 offset:12288
    ds_read_b64_tr_b16 v[58:59], v6 offset:12544
    ds_read_b128 v[88:91], v7 offset:384
    ds_read_b64_tr_b16 v[60:61], v6 offset:14336
    ds_read_b64_tr_b16 v[62:63], v6 offset:14592
    ds_read_b128 v[92:95], v7 offset:448
    s_waitcnt lgkmcnt(0)
    v_mfma_f32_16x16x32_bf16 v[8:11], v[32:35], v[64:67], 0
    v_mfma_f32_16x16x32_bf16 v[8:11], v[36:39], v[68:71], v[8:11]
    v_mfma_f32_16x16x32_bf16 v[8:11], v[40:43], v[72:75], v[8:11]
    v_mfma_f32_16x16x32_bf16 v[8:11], v[44:47], v[76:79], v[8:11]
    v_mfma_f32_16x16x32_bf16 v[8:11], v[48:51], v[80:83], v[8:11]
    v_mfma_f32_16x16x32_bf16 v[8:11], v[52:55], v[84:87], v[8:11]
    v_mfma_f32_16x16x32_bf16 v[8:11], v[56:59], v[88:91], v[8:11]
    v_mfma_f32_16x16x32_bf16 v[8:11], v[60:63], v[92:95], v[8:11]
    v_lshlrev_b32 v5, 15, v22
    v_lshl_add_u32 v5, v3, 4, v5
    s_lshr_b32 s75, s2, 4
    s_lshl_b32 s75, s75, 11
    s_and_b32 s76, s2, 7
    s_lshl_b32 s76, s76, 8
    s_add_u32 s75, s75, s76
    s_bfe_u32 s76, s2, 0x10003
    s_lshl_b32 s76, s76, 7
    s_add_u32 s75, s75, s76
    s_lshl_b32 s76, s3, 6
    s_add_u32 s75, s75, s76
    s_add_u32 s75, s75, 655360
    v_cmp_gt_u32 vcc, 8, v22
    s_and_saveexec_b64 s[82:83], vcc
    buffer_store_dwordx4 v[8:11], v5, s[40:43], s75 offen sc1
    s_mov_b64 exec, s[82:83]
L_t4:
    s_and_b32 s75, s2, 31
    s_cmp_lg_u32 s75, 0
    s_cbranch_scc1 L_exit
    s_lshr_b32 s77, s2, 5
    s_lshl_b32 s75, s77, 10
    v_lshlrev_b32 v4, 1, v0
    buffer_load_ushort v44, v4, s[44:47], s75 offen
    s_lshl_b32 s75, s77, 15
    s_add_u32 s75, s75, 655360
    s_mov_b32 s90, 0
    v_lshlrev_b32 v3, 2, v0
L_wppoll:
    s_add_u32 s76, s75, 0
    buffer_load_dword v16, v3, s[40:43], s76 offen sc1
    s_add_u32 s76, s75, 2048
    buffer_load_dword v17, v3, s[40:43], s76 offen sc1
    s_add_u32 s76, s75, 4096
    buffer_load_dword v18, v3, s[40:43], s76 offen sc1
    s_add_u32 s76, s75, 6144
    buffer_load_dword v19, v3, s[40:43], s76 offen sc1
    s_add_u32 s76, s75, 8192
    buffer_load_dword v20, v3, s[40:43], s76 offen sc1
    s_add_u32 s76, s75, 10240
    buffer_load_dword v21, v3, s[40:43], s76 offen sc1
    s_add_u32 s76, s75, 12288
    buffer_load_dword v22, v3, s[40:43], s76 offen sc1
    s_add_u32 s76, s75, 14336
    buffer_load_dword v23, v3, s[40:43], s76 offen sc1
    s_add_u32 s76, s75, 16384
    buffer_load_dword v24, v3, s[40:43], s76 offen sc1
    s_add_u32 s76, s75, 18432
    buffer_load_dword v25, v3, s[40:43], s76 offen sc1
    s_add_u32 s76, s75, 20480
    buffer_load_dword v26, v3, s[40:43], s76 offen sc1
    s_add_u32 s76, s75, 22528
    buffer_load_dword v27, v3, s[40:43], s76 offen sc1
    s_add_u32 s76, s75, 24576
    buffer_load_dword v28, v3, s[40:43], s76 offen sc1
    s_add_u32 s76, s75, 26624
    buffer_load_dword v29, v3, s[40:43], s76 offen sc1
    s_add_u32 s76, s75, 28672
    buffer_load_dword v30, v3, s[40:43], s76 offen sc1
    s_add_u32 s76, s75, 30720
    buffer_load_dword v31, v3, s[40:43], s76 offen sc1
    s_waitcnt vmcnt(0)
    v_max_u32 v40, v16, v17
    v_max3_u32 v40, v40, v18, v19
    v_max3_u32 v40, v40, v20, v21
    v_max3_u32 v40, v40, v22, v23
    v_max3_u32 v40, v40, v24, v25
    v_max3_u32 v40, v40, v26, v27
    v_max3_u32 v40, v40, v28, v29
    v_max3_u32 v40, v40, v30, v31
    v_cmp_eq_u32 vcc, -1, v40
    s_nop 1
    s_cmp_eq_u64 vcc, 0
    s_cbranch_scc1 L_wpok
    s_add_u32 s90, s90, 1
    s_cmp_ge_u32 s90, 400000
    s_cbranch_scc1 L_wpok
    s_sleep 1
    s_branch L_wppoll
L_wpok:
    v_add_f32 v16, v16, v17
    v_add_f32 v16, v16, v18
    v_add_f32 v16, v16, v19
    v_add_f32 v16, v16, v20
    v_add_f32 v16, v16, v21
    v_add_f32 v16, v16, v22
    v_add_f32 v16, v16, v23
    v_add_f32 v16, v16, v24
    v_add_f32 v16, v16, v25
    v_add_f32 v16, v16, v26
    v_add_f32 v16, v16, v27
    v_add_f32 v16, v16, v28
    v_add_f32 v16, v16, v29
    v_add_f32 v16, v16, v30
    v_add_f32 v16, v16, v31
    v_cvt_pk_bf16_f32 v16, v16, v16
    v_lshlrev_b32 v16, 16, v16
    v_lshlrev_b32 v44, 16, v44
    v_add_f32 v16, v16, v44
    v_cvt_pk_bf16_f32 v16, v16, v16
    v_lshlrev_b32 v16, 16, v16
    v_add_u32 v4, 161792, v3
    ds_write_b32 v4, v16
    s_waitcnt lgkmcnt(0)
    s_cbranch_execz L_skipB5
    s_barrier
L_skipB5:
    s_cmp_lg_u32 s101, 0
    s_cbranch_scc1 L_exit
    v_lshlrev_b32 v7, 5, v2
    v_add_u32 v7, 161792, v7
    ds_read_b128 v[16:19], v7
    ds_read_b128 v[20:23], v7 offset:16
    s_waitcnt lgkmcnt(0)
    v_mov_b32 v200, v16
    v_mov_b32 v201, v17
    v_mov_b32 v202, v18
    v_mov_b32 v203, v19
    v_mov_b32 v204, v20
    v_mov_b32 v205, v21
    v_mov_b32 v206, v22
    v_mov_b32 v207, v23
    v_add_f32 v64, v16, v17
    v_add_f32 v64, v64, v18
    v_add_f32 v64, v64, v19
    v_add_f32 v64, v64, v20
    v_add_f32 v64, v64, v21
    v_add_f32 v64, v64, v22
    v_add_f32 v64, v64, v23
    s_nop 1
    v_add_f32_dpp v64, v64, v64 quad_perm:[1,0,3,2] row_mask:0xf bank_mask:0xf
    s_nop 1
    v_add_f32_dpp v64, v64, v64 quad_perm:[2,3,0,1] row_mask:0xf bank_mask:0xf
    s_nop 1
    v_add_f32_dpp v64, v64, v64 row_half_mirror row_mask:0xf bank_mask:0xf
    s_nop 1
    v_add_f32_dpp v64, v64, v64 row_mirror row_mask:0xf bank_mask:0xf
    s_nop 1
    v_readlane_b32 s92, v64, 0
    v_readlane_b32 s93, v64, 16
    v_readlane_b32 s94, v64, 32
    v_readlane_b32 s95, v64, 48
    s_nop 1
    v_mov_b32 v65, s92
    v_add_f32 v65, s93, v65
    v_add_f32 v64, s94, v65
    v_add_f32 v64, s95, v64
    v_mul_f32 v64, 0x3b000000, v64
    v_sub_f32 v66, v16, v64
    v_sub_f32 v67, v17, v64
    v_sub_f32 v68, v18, v64
    v_sub_f32 v69, v19, v64
    v_sub_f32 v70, v20, v64
    v_sub_f32 v71, v21, v64
    v_sub_f32 v72, v22, v64
    v_sub_f32 v73, v23, v64
    v_mul_f32 v74, v66, v66
    v_fmac_f32 v74, v67, v67
    v_fmac_f32 v74, v68, v68
    v_fmac_f32 v74, v69, v69
    v_fmac_f32 v74, v70, v70
    v_fmac_f32 v74, v71, v71
    v_fmac_f32 v74, v72, v72
    v_fmac_f32 v74, v73, v73
    s_nop 1
    v_add_f32_dpp v74, v74, v74 quad_perm:[1,0,3,2] row_mask:0xf bank_mask:0xf
    s_nop 1
    v_add_f32_dpp v74, v74, v74 quad_perm:[2,3,0,1] row_mask:0xf bank_mask:0xf
    s_nop 1
    v_add_f32_dpp v74, v74, v74 row_half_mirror row_mask:0xf bank_mask:0xf
    s_nop 1
    v_add_f32_dpp v74, v74, v74 row_mirror row_mask:0xf bank_mask:0xf
    s_nop 1
    v_readlane_b32 s92, v74, 0
    v_readlane_b32 s93, v74, 16
    v_readlane_b32 s94, v74, 32
    v_readlane_b32 s95, v74, 48
    s_nop 1
    v_mov_b32 v65, s92
    v_add_f32 v65, s93, v65
    v_add_f32 v74, s94, v65
    v_add_f32 v74, s95, v74
    v_mul_f32 v74, 0x3b000000, v74
    v_cvt_pk_bf16_f32 v74, v74, v74
    v_lshlrev_b32 v74, 16, v74
    v_add_f32 v74, 0x3727c5ac, v74
    v_cvt_pk_bf16_f32 v74, v74, v74
    v_lshlrev_b32 v74, 16, v74
    v_sqrt_f32 v74, v74
    s_nop 0
    v_cvt_pk_bf16_f32 v74, v74, v74
    v_lshlrev_b32 v74, 16, v74
    v_rcp_f32 v75, v74
    v_cvt_pk_bf16_f32 v64, v64, v64
    v_lshlrev_b32 v64, 16, v64
    v_sub_f32 v16, v16, v64
    v_sub_f32 v17, v17, v64
    v_sub_f32 v18, v18, v64
    v_sub_f32 v19, v19, v64
    v_sub_f32 v20, v20, v64
    v_sub_f32 v21, v21, v64
    v_sub_f32 v22, v22, v64
    v_sub_f32 v23, v23, v64
    v_cvt_pk_bf16_f32 v66, v16, v17
    v_lshlrev_b32 v16, 16, v66
    v_and_b32 v17, 0xffff0000, v66
    v_cvt_pk_bf16_f32 v66, v18, v19
    v_lshlrev_b32 v18, 16, v66
    v_and_b32 v19, 0xffff0000, v66
    v_cvt_pk_bf16_f32 v66, v20, v21
    v_lshlrev_b32 v20, 16, v66
    v_and_b32 v21, 0xffff0000, v66
    v_cvt_pk_bf16_f32 v66, v22, v23
    v_lshlrev_b32 v22, 16, v66
    v_and_b32 v23, 0xffff0000, v66
    v_mul_f32 v66, v16, v75
    v_fma_f32 v67, -v66, v74, v16
    v_fma_f32 v16, v67, v75, v66
    v_mul_f32 v66, v17, v75
    v_fma_f32 v67, -v66, v74, v17
    v_fma_f32 v17, v67, v75, v66
    v_mul_f32 v66, v18, v75
    v_fma_f32 v67, -v66, v74, v18
    v_fma_f32 v18, v67, v75, v66
    v_mul_f32 v66, v19, v75
    v_fma_f32 v67, -v66, v74, v19
    v_fma_f32 v19, v67, v75, v66
    v_mul_f32 v66, v20, v75
    v_fma_f32 v67, -v66, v74, v20
    v_fma_f32 v20, v67, v75, v66
    v_mul_f32 v66, v21, v75
    v_fma_f32 v67, -v66, v74, v21
    v_fma_f32 v21, v67, v75, v66
    v_mul_f32 v66, v22, v75
    v_fma_f32 v67, -v66, v74, v22
    v_fma_f32 v22, v67, v75, v66
    v_mul_f32 v66, v23, v75
    v_fma_f32 v67, -v66, v74, v23
    v_fma_f32 v23, v67, v75, v66
    v_cvt_pk_bf16_f32 v66, v16, v17
    v_lshlrev_b32 v16, 16, v66
    v_and_b32 v17, 0xffff0000, v66
    v_cvt_pk_bf16_f32 v66, v18, v19
    v_lshlrev_b32 v18, 16, v66
    v_and_b32 v19, 0xffff0000, v66
    v_cvt_pk_bf16_f32 v66, v20, v21
    v_lshlrev_b32 v20, 16, v66
    v_and_b32 v21, 0xffff0000, v66
    v_cvt_pk_bf16_f32 v66, v22, v23
    v_lshlrev_b32 v22, 16, v66
    v_and_b32 v23, 0xffff0000, v66
    v_add_f32 v64, v16, v17
    v_add_f32 v64, v64, v18
    v_add_f32 v64, v64, v19
    v_add_f32 v64, v64, v20
    v_add_f32 v64, v64, v21
    v_add_f32 v64, v64, v22
    v_add_f32 v64, v64, v23
    s_nop 1
    v_add_f32_dpp v64, v64, v64 quad_perm:[1,0,3,2] row_mask:0xf bank_mask:0xf
    s_nop 1
    v_add_f32_dpp v64, v64, v64 quad_perm:[2,3,0,1] row_mask:0xf bank_mask:0xf
    s_nop 1
    v_add_f32_dpp v64, v64, v64 row_half_mirror row_mask:0xf bank_mask:0xf
    s_nop 1
    v_add_f32_dpp v64, v64, v64 row_mirror row_mask:0xf bank_mask:0xf
    s_nop 1
    v_readlane_b32 s92, v64, 0
    v_readlane_b32 s93, v64, 16
    v_readlane_b32 s94, v64, 32
    v_readlane_b32 s95, v64, 48
    s_nop 1
    v_mov_b32 v65, s92
    v_add_f32 v65, s93, v65
    v_add_f32 v64, s94, v65
    v_add_f32 v64, s95, v64
    v_mul_f32 v64, 0x3b000000, v64
    v_sub_f32 v66, v16, v64
    v_sub_f32 v67, v17, v64
    v_sub_f32 v68, v18, v64
    v_sub_f32 v69, v19, v64
    v_sub_f32 v70, v20, v64
    v_sub_f32 v71, v21, v64
    v_sub_f32 v72, v22, v64
    v_sub_f32 v73, v23, v64
    v_mul_f32 v74, v66, v66
    v_fmac_f32 v74, v67, v67
    v_fmac_f32 v74, v68, v68
    v_fmac_f32 v74, v69, v69
    v_fmac_f32 v74, v70, v70
    v_fmac_f32 v74, v71, v71
    v_fmac_f32 v74, v72, v72
    v_fmac_f32 v74, v73, v73
    s_nop 1
    v_add_f32_dpp v74, v74, v74 quad_perm:[1,0,3,2] row_mask:0xf bank_mask:0xf
    s_nop 1
    v_add_f32_dpp v74, v74, v74 quad_perm:[2,3,0,1] row_mask:0xf bank_mask:0xf
    s_nop 1
    v_add_f32_dpp v74, v74, v74 row_half_mirror row_mask:0xf bank_mask:0xf
    s_nop 1
    v_add_f32_dpp v74, v74, v74 row_mirror row_mask:0xf bank_mask:0xf
    s_nop 1
    v_readlane_b32 s92, v74, 0
    v_readlane_b32 s93, v74, 16
    v_readlane_b32 s94, v74, 32
    v_readlane_b32 s95, v74, 48
    s_nop 1
    v_mov_b32 v65, s92
    v_add_f32 v65, s93, v65
    v_add_f32 v74, s94, v65
    v_add_f32 v74, s95, v74
    v_mul_f32 v74, 0x3b000000, v74
    v_cvt_pk_bf16_f32 v74, v74, v74
    v_lshlrev_b32 v74, 16, v74
    v_add_f32 v74, 0x3727c5ac, v74
    v_cvt_pk_bf16_f32 v74, v74, v74
    v_lshlrev_b32 v74, 16, v74
    v_sqrt_f32 v74, v74
    s_nop 0
    v_cvt_pk_bf16_f32 v74, v74, v74
    v_lshlrev_b32 v74, 16, v74
    v_rcp_f32 v75, v74
    v_cvt_pk_bf16_f32 v64, v64, v64
    v_lshlrev_b32 v64, 16, v64
    v_sub_f32 v16, v16, v64
    v_sub_f32 v17, v17, v64
    v_sub_f32 v18, v18, v64
    v_sub_f32 v19, v19, v64
    v_sub_f32 v20, v20, v64
    v_sub_f32 v21, v21, v64
    v_sub_f32 v22, v22, v64
    v_sub_f32 v23, v23, v64
    v_cvt_pk_bf16_f32 v66, v16, v17
    v_lshlrev_b32 v16, 16, v66
    v_and_b32 v17, 0xffff0000, v66
    v_cvt_pk_bf16_f32 v66, v18, v19
    v_lshlrev_b32 v18, 16, v66
    v_and_b32 v19, 0xffff0000, v66
    v_cvt_pk_bf16_f32 v66, v20, v21
    v_lshlrev_b32 v20, 16, v66
    v_and_b32 v21, 0xffff0000, v66
    v_cvt_pk_bf16_f32 v66, v22, v23
    v_lshlrev_b32 v22, 16, v66
    v_and_b32 v23, 0xffff0000, v66
    v_mul_f32 v66, v16, v75
    v_fma_f32 v67, -v66, v74, v16
    v_fma_f32 v16, v67, v75, v66
    v_mul_f32 v66, v17, v75
    v_fma_f32 v67, -v66, v74, v17
    v_fma_f32 v17, v67, v75, v66
    v_mul_f32 v66, v18, v75
    v_fma_f32 v67, -v66, v74, v18
    v_fma_f32 v18, v67, v75, v66
    v_mul_f32 v66, v19, v75
    v_fma_f32 v67, -v66, v74, v19
    v_fma_f32 v19, v67, v75, v66
    v_mul_f32 v66, v20, v75
    v_fma_f32 v67, -v66, v74, v20
    v_fma_f32 v20, v67, v75, v66
    v_mul_f32 v66, v21, v75
    v_fma_f32 v67, -v66, v74, v21
    v_fma_f32 v21, v67, v75, v66
    v_mul_f32 v66, v22, v75
    v_fma_f32 v67, -v66, v74, v22
    v_fma_f32 v22, v67, v75, v66
    v_mul_f32 v66, v23, v75
    v_fma_f32 v67, -v66, v74, v23
    v_fma_f32 v23, v67, v75, v66
    v_cvt_pk_bf16_f32 v66, v16, v17
    v_lshlrev_b32 v16, 16, v66
    v_and_b32 v17, 0xffff0000, v66
    v_cvt_pk_bf16_f32 v66, v18, v19
    v_lshlrev_b32 v18, 16, v66
    v_and_b32 v19, 0xffff0000, v66
    v_cvt_pk_bf16_f32 v66, v20, v21
    v_lshlrev_b32 v20, 16, v66
    v_and_b32 v21, 0xffff0000, v66
    v_cvt_pk_bf16_f32 v66, v22, v23
    v_lshlrev_b32 v22, 16, v66
    v_and_b32 v23, 0xffff0000, v66
    s_mov_b32 s76, 1179648
    s_mov_b32 s75, 4096
    s_mov_b64 s[20:21], 0
    v_mov_b32 v34, 8192
    v_bfe_u32 v24, v16, 16, 15
    v_lshrrev_b32 v32, 31, v16
    v_subrev_u32 v25, 12800, v24
    v_cmp_eq_u32 vcc, 0, v24
    v_cmp_le_u32 s[82:83], s75, v25
    v_mad_u32_u24 v33, v32, s75, v25
    s_nop 1
    v_cndmask_b32 v33, v33, v34, s[82:83]
    s_andn2_b64 s[82:83], s[82:83], vcc
    s_or_b64 s[20:21], s[20:21], s[82:83]
    v_lshlrev_b32 v33, 2, v33
    buffer_load_dword v208, v33, s[40:43], s76 offen sc1
    v_bfe_u32 v24, v17, 16, 15
    v_lshrrev_b32 v32, 31, v17
    v_subrev_u32 v25, 12800, v24
    v_cmp_eq_u32 vcc, 0, v24
    v_cmp_le_u32 s[82:83], s75, v25
    v_mad_u32_u24 v33, v32, s75, v25
    s_nop 1
    v_cndmask_b32 v33, v33, v34, s[82:83]
    s_andn2_b64 s[82:83], s[82:83], vcc
    s_or_b64 s[20:21], s[20:21], s[82:83]
    v_lshlrev_b32 v33, 2, v33
    buffer_load_dword v209, v33, s[40:43], s76 offen sc1
    v_bfe_u32 v24, v18, 16, 15
    v_lshrrev_b32 v32, 31, v18
    v_subrev_u32 v25, 12800, v24
    v_cmp_eq_u32 vcc, 0, v24
    v_cmp_le_u32 s[82:83], s75, v25
    v_mad_u32_u24 v33, v32, s75, v25
    s_nop 1
    v_cndmask_b32 v33, v33, v34, s[82:83]
    s_andn2_b64 s[82:83], s[82:83], vcc
    s_or_b64 s[20:21], s[20:21], s[82:83]
    v_lshlrev_b32 v33, 2, v33
    buffer_load_dword v210, v33, s[40:43], s76 offen sc1
    v_bfe_u32 v24, v19, 16, 15
    v_lshrrev_b32 v32, 31, v19
    v_subrev_u32 v25, 12800, v24
    v_cmp_eq_u32 vcc, 0, v24
    v_cmp_le_u32 s[82:83], s75, v25
    v_mad_u32_u24 v33, v32, s75, v25
    s_nop 1
    v_cndmask_b32 v33, v33, v34, s[82:83]
    s_andn2_b64 s[82:83], s[82:83], vcc
    s_or_b64 s[20:21], s[20:21], s[82:83]
    v_lshlrev_b32 v33, 2, v33
    buffer_load_dword v211, v33, s[40:43], s76 offen sc1
    v_bfe_u32 v24, v20, 16, 15
    v_lshrrev_b32 v32, 31, v20
    v_subrev_u32 v25, 12800, v24
    v_cmp_eq_u32 vcc, 0, v24
    v_cmp_le_u32 s[82:83], s75, v25
    v_mad_u32_u24 v33, v32, s75, v25
    s_nop 1
    v_cndmask_b32 v33, v33, v34, s[82:83]
    s_andn2_b64 s[82:83], s[82:83], vcc
    s_or_b64 s[20:21], s[20:21], s[82:83]
    v_lshlrev_b32 v33, 2, v33
    buffer_load_dword v212, v33, s[40:43], s76 offen sc1
    v_bfe_u32 v24, v21, 16, 15
    v_lshrrev_b32 v32, 31, v21
    v_subrev_u32 v25, 12800, v24
    v_cmp_eq_u32 vcc, 0, v24
    v_cmp_le_u32 s[82:83], s75, v25
    v_mad_u32_u24 v33, v32, s75, v25
    s_nop 1
    v_cndmask_b32 v33, v33, v34, s[82:83]
    s_andn2_b64 s[82:83], s[82:83], vcc
    s_or_b64 s[20:21], s[20:21], s[82:83]
    v_lshlrev_b32 v33, 2, v33
    buffer_load_dword v213, v33, s[40:43], s76 offen sc1
    v_bfe_u32 v24, v22, 16, 15
    v_lshrrev_b32 v32, 31, v22
    v_subrev_u32 v25, 12800, v24
    v_cmp_eq_u32 vcc, 0, v24
    v_cmp_le_u32 s[82:83], s75, v25
    v_mad_u32_u24 v33, v32, s75, v25
    s_nop 1
    v_cndmask_b32 v33, v33, v34, s[82:83]
    s_andn2_b64 s[82:83], s[82:83], vcc
    s_or_b64 s[20:21], s[20:21], s[82:83]
    v_lshlrev_b32 v33, 2, v33
    buffer_load_dword v214, v33, s[40:43], s76 offen sc1
    v_bfe_u32 v24, v23, 16, 15
    v_lshrrev_b32 v32, 31, v23
    v_subrev_u32 v25, 12800, v24
    v_cmp_eq_u32 vcc, 0, v24
    v_cmp_le_u32 s[82:83], s75, v25
    v_mad_u32_u24 v33, v32, s75, v25
    s_nop 1
    v_cndmask_b32 v33, v33, v34, s[82:83]
    s_andn2_b64 s[82:83], s[82:83], vcc
    s_or_b64 s[20:21], s[20:21], s[82:83]
    v_lshlrev_b32 v33, 2, v33
    buffer_load_dword v215, v33, s[40:43], s76 offen sc1
    s_waitcnt vmcnt(0)
    s_cmp_eq_u64 s[20:21], 0
    s_cbranch_scc1 L_fast
    v_lshlrev_b32 v7, 5, v2
    v_add_u32 v8, 131072, v7
    v_add_u32 v9, 133120, v7
    ds_write_b128 v8, v[16:19]
    ds_write_b128 v8, v[20:23] offset:16
    ds_write_b128 v9, v[208:211]
    ds_write_b128 v9, v[212:215] offset:16
    v_mul_u32_u24 v13, 56, v2
    buffer_load_dwordx4 v[160:163], v13, s[52:55], 0 offen
    buffer_load_dwordx4 v[164:167], v13, s[52:55], 0 offen offset:16
    buffer_load_dwordx4 v[168:171], v13, s[52:55], 0 offen offset:32
    buffer_load_dwordx2 v[172:173], v13, s[52:55], 0 offen offset:48
    buffer_load_dwordx4 v[176:179], v13, s[56:59], 0 offen
    buffer_load_dwordx4 v[180:183], v13, s[56:59], 0 offen offset:16
    buffer_load_dwordx4 v[184:187], v13, s[56:59], 0 offen offset:32
    buffer_load_dwordx2 v[188:189], v13, s[56:59], 0 offen offset:48
    buffer_load_dwordx4 v[96:99], v13, s[60:63], 0 offen
    buffer_load_dwordx4 v[100:103], v13, s[60:63], 0 offen offset:16
    buffer_load_dwordx4 v[104:107], v13, s[60:63], 0 offen offset:32
    buffer_load_dwordx2 v[108:109], v13, s[60:63], 0 offen offset:48
    v_mov_b32 v13, 0
    buffer_load_ushort v192, v13, s[64:67], 0 offen
    s_waitcnt vmcnt(0) lgkmcnt(0)
    s_mov_b32 s12, 0xc0135761
    s_mov_b32 s14, 0xbdd2d3e8
    s_mov_b32 s15, 0xbdd2d3e8
    v_mov_b32 v38, s12
    v_mov_b32 v39, s12
    v_and_b32 v41, 0xffff0000, v160
    v_lshlrev_b32 v40, 16, v160
    v_and_b32 v69, 0xffff0000, v176
    v_lshlrev_b32 v68, 16, v176
    v_and_b32 v43, 0xffff0000, v161
    v_lshlrev_b32 v42, 16, v161
    v_and_b32 v71, 0xffff0000, v177
    v_lshlrev_b32 v70, 16, v177
    v_and_b32 v45, 0xffff0000, v162
    v_lshlrev_b32 v44, 16, v162
    v_and_b32 v73, 0xffff0000, v178
    v_lshlrev_b32 v72, 16, v178
    v_and_b32 v47, 0xffff0000, v163
    v_lshlrev_b32 v46, 16, v163
    v_and_b32 v75, 0xffff0000, v179
    v_lshlrev_b32 v74, 16, v179
    v_and_b32 v49, 0xffff0000, v164
    v_lshlrev_b32 v48, 16, v164
    v_and_b32 v77, 0xffff0000, v180
    v_lshlrev_b32 v76, 16, v180
    v_and_b32 v51, 0xffff0000, v165
    v_lshlrev_b32 v50, 16, v165
    v_and_b32 v79, 0xffff0000, v181
    v_lshlrev_b32 v78, 16, v181
    v_and_b32 v53, 0xffff0000, v166
    v_lshlrev_b32 v52, 16, v166
    v_and_b32 v81, 0xffff0000, v182
    v_lshlrev_b32 v80, 16, v182
    v_and_b32 v55, 0xffff0000, v167
    v_lshlrev_b32 v54, 16, v167
    v_and_b32 v83, 0xffff0000, v183
    v_lshlrev_b32 v82, 16, v183
    v_and_b32 v57, 0xffff0000, v168
    v_lshlrev_b32 v56, 16, v168
    v_and_b32 v85, 0xffff0000, v184
    v_lshlrev_b32 v84, 16, v184
    v_and_b32 v59, 0xffff0000, v169
    v_lshlrev_b32 v58, 16, v169
    v_and_b32 v87, 0xffff0000, v185
    v_lshlrev_b32 v86, 16, v185
    v_and_b32 v61, 0xffff0000, v170
    v_lshlrev_b32 v60, 16, v170
    v_and_b32 v89, 0xffff0000, v186
    v_lshlrev_b32 v88, 16, v186
    v_and_b32 v63, 0xffff0000, v171
    v_lshlrev_b32 v62, 16, v171
    v_and_b32 v91, 0xffff0000, v187
    v_lshlrev_b32 v90, 16, v187
    v_and_b32 v65, 0xffff0000, v172
    v_lshlrev_b32 v64, 16, v172
    v_and_b32 v93, 0xffff0000, v188
    v_lshlrev_b32 v92, 16, v188
    v_and_b32 v67, 0xffff0000, v173
    v_lshlrev_b32 v66, 16, v173
    v_and_b32 v95, 0xffff0000, v189
    v_lshlrev_b32 v94, 16, v189
    v_lshlrev_b32 v36, 16, v192
    s_mov_b32 s20, 0
L_sloop:
    s_lshl_b32 s21, s20, 2
    s_add_u32 s21, s21, 131072
    v_mov_b32 v10, s21
    ds_read_b32 v11, v10
    s_waitcnt lgkmcnt(0)
    v_readfirstlane_b32 s4, v11
    s_bfe_u32 s21, s4, 0xf0010
    s_cmp_eq_u32 s21, 0
    s_cbranch_scc1 L_snext
    s_sub_u32 s21, s21, 12800
    s_cmp_lt_u32 s21, 4096
    s_cbranch_scc1 L_snext
    s_mov_b32 s5, s4
    v_mov_b32 v112, 0
    v_pk_mul_f32 v[116:117], v[40:41], s[4:5]
    v_pk_mul_f32 v[122:123], v[42:43], s[4:5]
    v_pk_mul_f32 v[128:129], v[44:45], s[4:5]
    v_pk_mul_f32 v[134:135], v[46:47], s[4:5]
    v_pk_mul_f32 v[140:141], v[48:49], s[4:5]
    v_pk_mul_f32 v[146:147], v[50:51], s[4:5]
    v_pk_mul_f32 v[152:153], v[52:53], s[4:5]
    v_cvt_pk_bf16_f32 v120, v116, v117
    v_cvt_pk_bf16_f32 v126, v122, v123
    v_cvt_pk_bf16_f32 v132, v128, v129
    v_cvt_pk_bf16_f32 v138, v134, v135
    v_cvt_pk_bf16_f32 v144, v140, v141
    v_cvt_pk_bf16_f32 v150, v146, v147
    v_cvt_pk_bf16_f32 v156, v152, v153
    v_lshlrev_b32 v116, 16, v120
    v_lshlrev_b32 v122, 16, v126
    v_lshlrev_b32 v128, 16, v132
    v_lshlrev_b32 v134, 16, v138
    v_lshlrev_b32 v140, 16, v144
    v_lshlrev_b32 v146, 16, v150
    v_lshlrev_b32 v152, 16, v156
    v_and_b32 v117, 0xffff0000, v120
    v_and_b32 v123, 0xffff0000, v126
    v_and_b32 v129, 0xffff0000, v132
    v_and_b32 v135, 0xffff0000, v138
    v_and_b32 v141, 0xffff0000, v144
    v_and_b32 v147, 0xffff0000, v150
    v_and_b32 v153, 0xffff0000, v156
    v_pk_add_f32 v[116:117], v[116:117], v[68:69]
    v_pk_add_f32 v[122:123], v[122:123], v[70:71]
    v_pk_add_f32 v[128:129], v[128:129], v[72:73]
    v_pk_add_f32 v[134:135], v[134:135], v[74:75]
    v_pk_add_f32 v[140:141], v[140:141], v[76:77]
    v_pk_add_f32 v[146:147], v[146:147], v[78:79]
    v_pk_add_f32 v[152:153], v[152:153], v[80:81]
    v_cvt_pk_bf16_f32 v120, v116, v117
    v_cvt_pk_bf16_f32 v126, v122, v123
    v_cvt_pk_bf16_f32 v132, v128, v129
    v_cvt_pk_bf16_f32 v138, v134, v135
    v_cvt_pk_bf16_f32 v144, v140, v141
    v_cvt_pk_bf16_f32 v150, v146, v147
    v_cvt_pk_bf16_f32 v156, v152, v153
    v_lshlrev_b32 v116, 16, v120
    v_lshlrev_b32 v122, 16, v126
    v_lshlrev_b32 v128, 16, v132
    v_lshlrev_b32 v134, 16, v138
    v_lshlrev_b32 v140, 16, v144
    v_lshlrev_b32 v146, 16, v150
    v_lshlrev_b32 v152, 16, v156
    v_and_b32 v117, 0xffff0000, v120
    v_and_b32 v123, 0xffff0000, v126
    v_and_b32 v129, 0xffff0000, v132
    v_and_b32 v135, 0xffff0000, v138
    v_and_b32 v141, 0xffff0000, v144
    v_and_b32 v147, 0xffff0000, v150
    v_and_b32 v153, 0xffff0000, v156
    v_pk_mul_f32 v[118:119], v[116:117], v[116:117]
    v_pk_mul_f32 v[124:125], v[122:123], v[122:123]
    v_pk_mul_f32 v[130:131], v[128:129], v[128:129]
    v_pk_mul_f32 v[136:137], v[134:135], v[134:135]
    v_pk_mul_f32 v[142:143], v[140:141], v[140:141]
    v_pk_mul_f32 v[148:149], v[146:147], v[146:147]
    v_pk_mul_f32 v[154:155], v[152:153], v[152:153]
    v_pk_fma_f32 v[118:119], v[118:119], s[14:15], v[38:39]
    v_pk_fma_f32 v[124:125], v[124:125], s[14:15], v[38:39]
    v_pk_fma_f32 v[130:131], v[130:131], s[14:15], v[38:39]
    v_pk_fma_f32 v[136:137], v[136:137], s[14:15], v[38:39]
    v_pk_fma_f32 v[142:143], v[142:143], s[14:15], v[38:39]
    v_pk_fma_f32 v[148:149], v[148:149], s[14:15], v[38:39]
    v_pk_fma_f32 v[154:155], v[154:155], s[14:15], v[38:39]
    v_pk_mul_f32 v[118:119], v[118:119], v[116:117]
    v_pk_mul_f32 v[124:125], v[124:125], v[122:123]
    v_pk_mul_f32 v[130:131], v[130:131], v[128:129]
    v_pk_mul_f32 v[136:137], v[136:137], v[134:135]
    v_pk_mul_f32 v[142:143], v[142:143], v[140:141]
    v_pk_mul_f32 v[148:149], v[148:149], v[146:147]
    v_pk_mul_f32 v[154:155], v[154:155], v[152:153]
    v_exp_f32 v118, v118
    v_exp_f32 v124, v124
    v_exp_f32 v130, v130
    v_exp_f32 v136, v136
    v_exp_f32 v142, v142
    v_exp_f32 v148, v148
    v_exp_f32 v154, v154
    v_exp_f32 v119, v119
    v_exp_f32 v125, v125
    v_exp_f32 v131, v131
    v_exp_f32 v137, v137
    v_exp_f32 v143, v143
    v_exp_f32 v149, v149
    v_exp_f32 v155, v155
    v_pk_add_f32 v[118:119], v[118:119], 1.0 op_sel_hi:[1,0]
    v_pk_add_f32 v[124:125], v[124:125], 1.0 op_sel_hi:[1,0]
    v_pk_add_f32 v[130:131], v[130:131], 1.0 op_sel_hi:[1,0]
    v_pk_add_f32 v[136:137], v[136:137], 1.0 op_sel_hi:[1,0]
    v_pk_add_f32 v[142:143], v[142:143], 1.0 op_sel_hi:[1,0]
    v_pk_add_f32 v[148:149], v[148:149], 1.0 op_sel_hi:[1,0]
    v_pk_add_f32 v[154:155], v[154:155], 1.0 op_sel_hi:[1,0]
    v_rcp_f32 v118, v118
    v_rcp_f32 v124, v124
    v_rcp_f32 v130, v130
    v_rcp_f32 v136, v136
    v_rcp_f32 v142, v142
    v_rcp_f32 v148, v148
    v_rcp_f32 v154, v154
    v_rcp_f32 v119, v119
    v_rcp_f32 v125, v125
    v_rcp_f32 v131, v131
    v_rcp_f32 v137, v137
    v_rcp_f32 v143, v143
    v_rcp_f32 v149, v149
    v_rcp_f32 v155, v155
    v_pk_mul_f32 v[118:119], v[118:119], v[116:117]
    v_pk_mul_f32 v[124:125], v[124:125], v[122:123]
    v_pk_mul_f32 v[130:131], v[130:131], v[128:129]
    v_pk_mul_f32 v[136:137], v[136:137], v[134:135]
    v_pk_mul_f32 v[142:143], v[142:143], v[140:141]
    v_pk_mul_f32 v[148:149], v[148:149], v[146:147]
    v_pk_mul_f32 v[154:155], v[154:155], v[152:153]
    v_cvt_pk_bf16_f32 v120, v118, v119
    v_cvt_pk_bf16_f32 v126, v124, v125
    v_cvt_pk_bf16_f32 v132, v130, v131
    v_cvt_pk_bf16_f32 v138, v136, v137
    v_cvt_pk_bf16_f32 v144, v142, v143
    v_cvt_pk_bf16_f32 v150, v148, v149
    v_cvt_pk_bf16_f32 v156, v154, v155
    v_dot2_f32_bf16 v112, v120, v96, v112
    v_dot2_f32_bf16 v112, v126, v97, v112
    v_dot2_f32_bf16 v112, v132, v98, v112
    v_dot2_f32_bf16 v112, v138, v99, v112
    v_dot2_f32_bf16 v112, v144, v100, v112
    v_dot2_f32_bf16 v112, v150, v101, v112
    v_dot2_f32_bf16 v112, v156, v102, v112
    v_pk_mul_f32 v[116:117], v[54:55], s[4:5]
    v_pk_mul_f32 v[122:123], v[56:57], s[4:5]
    v_pk_mul_f32 v[128:129], v[58:59], s[4:5]
    v_pk_mul_f32 v[134:135], v[60:61], s[4:5]
    v_pk_mul_f32 v[140:141], v[62:63], s[4:5]
    v_pk_mul_f32 v[146:147], v[64:65], s[4:5]
    v_pk_mul_f32 v[152:153], v[66:67], s[4:5]
    v_cvt_pk_bf16_f32 v120, v116, v117
    v_cvt_pk_bf16_f32 v126, v122, v123
    v_cvt_pk_bf16_f32 v132, v128, v129
    v_cvt_pk_bf16_f32 v138, v134, v135
    v_cvt_pk_bf16_f32 v144, v140, v141
    v_cvt_pk_bf16_f32 v150, v146, v147
    v_cvt_pk_bf16_f32 v156, v152, v153
    v_lshlrev_b32 v116, 16, v120
    v_lshlrev_b32 v122, 16, v126
    v_lshlrev_b32 v128, 16, v132
    v_lshlrev_b32 v134, 16, v138
    v_lshlrev_b32 v140, 16, v144
    v_lshlrev_b32 v146, 16, v150
    v_lshlrev_b32 v152, 16, v156
    v_and_b32 v117, 0xffff0000, v120
    v_and_b32 v123, 0xffff0000, v126
    v_and_b32 v129, 0xffff0000, v132
    v_and_b32 v135, 0xffff0000, v138
    v_and_b32 v141, 0xffff0000, v144
    v_and_b32 v147, 0xffff0000, v150
    v_and_b32 v153, 0xffff0000, v156
    v_pk_add_f32 v[116:117], v[116:117], v[82:83]
    v_pk_add_f32 v[122:123], v[122:123], v[84:85]
    v_pk_add_f32 v[128:129], v[128:129], v[86:87]
    v_pk_add_f32 v[134:135], v[134:135], v[88:89]
    v_pk_add_f32 v[140:141], v[140:141], v[90:91]
    v_pk_add_f32 v[146:147], v[146:147], v[92:93]
    v_pk_add_f32 v[152:153], v[152:153], v[94:95]
    v_cvt_pk_bf16_f32 v120, v116, v117
    v_cvt_pk_bf16_f32 v126, v122, v123
    v_cvt_pk_bf16_f32 v132, v128, v129
    v_cvt_pk_bf16_f32 v138, v134, v135
    v_cvt_pk_bf16_f32 v144, v140, v141
    v_cvt_pk_bf16_f32 v150, v146, v147
    v_cvt_pk_bf16_f32 v156, v152, v153
    v_lshlrev_b32 v116, 16, v120
    v_lshlrev_b32 v122, 16, v126
    v_lshlrev_b32 v128, 16, v132
    v_lshlrev_b32 v134, 16, v138
    v_lshlrev_b32 v140, 16, v144
    v_lshlrev_b32 v146, 16, v150
    v_lshlrev_b32 v152, 16, v156
    v_and_b32 v117, 0xffff0000, v120
    v_and_b32 v123, 0xffff0000, v126
    v_and_b32 v129, 0xffff0000, v132
    v_and_b32 v135, 0xffff0000, v138
    v_and_b32 v141, 0xffff0000, v144
    v_and_b32 v147, 0xffff0000, v150
    v_and_b32 v153, 0xffff0000, v156
    v_pk_mul_f32 v[118:119], v[116:117], v[116:117]
    v_pk_mul_f32 v[124:125], v[122:123], v[122:123]
    v_pk_mul_f32 v[130:131], v[128:129], v[128:129]
    v_pk_mul_f32 v[136:137], v[134:135], v[134:135]
    v_pk_mul_f32 v[142:143], v[140:141], v[140:141]
    v_pk_mul_f32 v[148:149], v[146:147], v[146:147]
    v_pk_mul_f32 v[154:155], v[152:153], v[152:153]
    v_pk_fma_f32 v[118:119], v[118:119], s[14:15], v[38:39]
    v_pk_fma_f32 v[124:125], v[124:125], s[14:15], v[38:39]
    v_pk_fma_f32 v[130:131], v[130:131], s[14:15], v[38:39]
    v_pk_fma_f32 v[136:137], v[136:137], s[14:15], v[38:39]
    v_pk_fma_f32 v[142:143], v[142:143], s[14:15], v[38:39]
    v_pk_fma_f32 v[148:149], v[148:149], s[14:15], v[38:39]
    v_pk_fma_f32 v[154:155], v[154:155], s[14:15], v[38:39]
    v_pk_mul_f32 v[118:119], v[118:119], v[116:117]
    v_pk_mul_f32 v[124:125], v[124:125], v[122:123]
    v_pk_mul_f32 v[130:131], v[130:131], v[128:129]
    v_pk_mul_f32 v[136:137], v[136:137], v[134:135]
    v_pk_mul_f32 v[142:143], v[142:143], v[140:141]
    v_pk_mul_f32 v[148:149], v[148:149], v[146:147]
    v_pk_mul_f32 v[154:155], v[154:155], v[152:153]
    v_exp_f32 v118, v118
    v_exp_f32 v124, v124
    v_exp_f32 v130, v130
    v_exp_f32 v136, v136
    v_exp_f32 v142, v142
    v_exp_f32 v148, v148
    v_exp_f32 v154, v154
    v_exp_f32 v119, v119
    v_exp_f32 v125, v125
    v_exp_f32 v131, v131
    v_exp_f32 v137, v137
    v_exp_f32 v143, v143
    v_exp_f32 v149, v149
    v_exp_f32 v155, v155
    v_pk_add_f32 v[118:119], v[118:119], 1.0 op_sel_hi:[1,0]
    v_pk_add_f32 v[124:125], v[124:125], 1.0 op_sel_hi:[1,0]
    v_pk_add_f32 v[130:131], v[130:131], 1.0 op_sel_hi:[1,0]
    v_pk_add_f32 v[136:137], v[136:137], 1.0 op_sel_hi:[1,0]
    v_pk_add_f32 v[142:143], v[142:143], 1.0 op_sel_hi:[1,0]
    v_pk_add_f32 v[148:149], v[148:149], 1.0 op_sel_hi:[1,0]
    v_pk_add_f32 v[154:155], v[154:155], 1.0 op_sel_hi:[1,0]
    v_rcp_f32 v118, v118
    v_rcp_f32 v124, v124
    v_rcp_f32 v130, v130
    v_rcp_f32 v136, v136
    v_rcp_f32 v142, v142
    v_rcp_f32 v148, v148
    v_rcp_f32 v154, v154
    v_rcp_f32 v119, v119
    v_rcp_f32 v125, v125
    v_rcp_f32 v131, v131
    v_rcp_f32 v137, v137
    v_rcp_f32 v143, v143
    v_rcp_f32 v149, v149
    v_rcp_f32 v155, v155
    v_pk_mul_f32 v[118:119], v[118:119], v[116:117]
    v_pk_mul_f32 v[124:125], v[124:125], v[122:123]
    v_pk_mul_f32 v[130:131], v[130:131], v[128:129]
    v_pk_mul_f32 v[136:137], v[136:137], v[134:135]
    v_pk_mul_f32 v[142:143], v[142:143], v[140:141]
    v_pk_mul_f32 v[148:149], v[148:149], v[146:147]
    v_pk_mul_f32 v[154:155], v[154:155], v[152:153]
    v_cvt_pk_bf16_f32 v120, v118, v119
    v_cvt_pk_bf16_f32 v126, v124, v125
    v_cvt_pk_bf16_f32 v132, v130, v131
    v_cvt_pk_bf16_f32 v138, v136, v137
    v_cvt_pk_bf16_f32 v144, v142, v143
    v_cvt_pk_bf16_f32 v150, v148, v149
    v_cvt_pk_bf16_f32 v156, v154, v155
    v_dot2_f32_bf16 v112, v120, v103, v112
    v_dot2_f32_bf16 v112, v126, v104, v112
    v_dot2_f32_bf16 v112, v132, v105, v112
    v_dot2_f32_bf16 v112, v138, v106, v112
    v_dot2_f32_bf16 v112, v144, v107, v112
    v_dot2_f32_bf16 v112, v150, v108, v112
    v_dot2_f32_bf16 v112, v156, v109, v112
    s_nop 2
    s_nop 1
    v_add_f32_dpp v112, v112, v112 quad_perm:[1,0,3,2] row_mask:0xf bank_mask:0xf
    s_nop 1
    v_add_f32_dpp v112, v112, v112 quad_perm:[2,3,0,1] row_mask:0xf bank_mask:0xf
    s_nop 1
    v_add_f32_dpp v112, v112, v112 row_half_mirror row_mask:0xf bank_mask:0xf
    s_nop 1
    v_add_f32_dpp v112, v112, v112 row_mirror row_mask:0xf bank_mask:0xf
    s_nop 1
    v_add_f32_dpp v112, v112, v112 row_bcast:15 row_mask:0xa bank_mask:0xf
    s_nop 1
    v_add_f32_dpp v112, v112, v112 row_bcast:31 row_mask:0xc bank_mask:0xf
    v_cvt_pk_bf16_f32 v112, v112, v112
    v_lshlrev_b32 v112, 16, v112
    v_add_f32 v112, v112, v36
    v_cvt_pk_bf16_f32 v112, v112, v112
    v_lshlrev_b32 v112, 16, v112
    s_mov_b32 exec_lo, 0
    s_mov_b32 exec_hi, 0x80000000
    ds_write_b32 v10, v112 offset:2048
    s_mov_b64 exec, -1
L_snext:
    s_add_u32 s20, s20, 1
    s_cmp_lt_u32 s20, 512
    s_cbranch_scc1 L_sloop
    s_waitcnt lgkmcnt(0)
    ds_read_b128 v[208:211], v9
    ds_read_b128 v[212:215], v9 offset:16
    s_waitcnt lgkmcnt(0)
L_fast:
    v_add_f32 v208, v208, v200
    v_add_f32 v209, v209, v201
    v_add_f32 v210, v210, v202
    v_add_f32 v211, v211, v203
    v_add_f32 v212, v212, v204
    v_add_f32 v213, v213, v205
    v_add_f32 v214, v214, v206
    v_add_f32 v215, v215, v207
    v_cvt_pk_bf16_f32 v64, v208, v209
    v_cvt_pk_bf16_f32 v65, v210, v211
    v_cvt_pk_bf16_f32 v66, v212, v213
    v_cvt_pk_bf16_f32 v67, v214, v215
    v_lshlrev_b32 v8, 4, v2
    s_lshl_b32 s75, s77, 10
    buffer_store_dwordx4 v[64:67], v8, s[68:71], s75 offen
L_exit:
    s_cmp_eq_u32 s98, 0
    s_cbranch_scc1 L_exit2
    s_mov_b32 s98, 0
    s_mov_b32 s101, s3
    s_mov_b64 exec, -1
    s_branch L_b3
L_exit2:
    s_endpgm
L_rare0:
    ds_bpermute_b32 v129, v140, v128
    s_waitcnt lgkmcnt(0)
    v_max_f32 v128, v128, v129
    ds_bpermute_b32 v129, v141, v128
    s_waitcnt lgkmcnt(0)
    v_max3_f32 v128, v128, v129, v136
    v_sub_f32 v129, v136, v128
    v_mul_f32 v129, s81, v129
    v_exp_f32 v129, v129
    s_nop 0
    v_mul_f32 v144, v144, v129
    v_mul_f32 v145, v145, v129
    v_mul_f32 v146, v146, v129
    v_mul_f32 v147, v147, v129
    v_mul_f32 v148, v148, v129
    v_mul_f32 v149, v149, v129
    v_mul_f32 v150, v150, v129
    v_mul_f32 v151, v151, v129
    v_mul_f32 v152, v152, v129
    v_mul_f32 v153, v153, v129
    v_mul_f32 v154, v154, v129
    v_mul_f32 v155, v155, v129
    v_mul_f32 v156, v156, v129
    v_mul_f32 v157, v157, v129
    v_mul_f32 v158, v158, v129
    v_mul_f32 v159, v159, v129
    v_mul_f32 v160, v160, v129
    v_mul_f32 v161, v161, v129
    v_mul_f32 v162, v162, v129
    v_mul_f32 v163, v163, v129
    v_mul_f32 v164, v164, v129
    v_mul_f32 v165, v165, v129
    v_mul_f32 v166, v166, v129
    v_mul_f32 v167, v167, v129
    v_mul_f32 v168, v168, v129
    v_mul_f32 v169, v169, v129
    v_mul_f32 v170, v170, v129
    v_mul_f32 v171, v171, v129
    v_mul_f32 v172, v172, v129
    v_mul_f32 v173, v173, v129
    v_mul_f32 v174, v174, v129
    v_mul_f32 v175, v175, v129
    v_mul_f32 v139, v139, v129
    v_mov_b32 v136, v128
    v_mul_f32 v137, s81, v128
    v_sub_f32 v137, 0, v137
    v_add_f32 v138, 0x40a00000, v128
    s_branch L_back0
L_rare1:
    ds_bpermute_b32 v129, v140, v128
    s_waitcnt lgkmcnt(0)
    v_max_f32 v128, v128, v129
    ds_bpermute_b32 v129, v141, v128
    s_waitcnt lgkmcnt(0)
    v_max3_f32 v128, v128, v129, v136
    v_sub_f32 v129, v136, v128
    v_mul_f32 v129, s81, v129
    v_exp_f32 v129, v129
    s_nop 0
    v_mul_f32 v144, v144, v129
    v_mul_f32 v145, v145, v129
    v_mul_f32 v146, v146, v129
    v_mul_f32 v147, v147, v129
    v_mul_f32 v148, v148, v129
    v_mul_f32 v149, v149, v129
    v_mul_f32 v150, v150, v129
    v_mul_f32 v151, v151, v129
    v_mul_f32 v152, v152, v129
    v_mul_f32 v153, v153, v129
    v_mul_f32 v154, v154, v129
    v_mul_f32 v155, v155, v129
    v_mul_f32 v156, v156, v129
    v_mul_f32 v157, v157, v129
    v_mul_f32 v158, v158, v129
    v_mul_f32 v159, v159, v129
    v_mul_f32 v160, v160, v129
    v_mul_f32 v161, v161, v129
    v_mul_f32 v162, v162, v129
    v_mul_f32 v163, v163, v129
    v_mul_f32 v164, v164, v129
    v_mul_f32 v165, v165, v129
    v_mul_f32 v166, v166, v129
    v_mul_f32 v167, v167, v129
    v_mul_f32 v168, v168, v129
    v_mul_f32 v169, v169, v129
    v_mul_f32 v170, v170, v129
    v_mul_f32 v171, v171, v129
    v_mul_f32 v172, v172, v129
    v_mul_f32 v173, v173, v129
    v_mul_f32 v174, v174, v129
    v_mul_f32 v175, v175, v129
    v_mul_f32 v139, v139, v129
    v_mov_b32 v136, v128
    v_mul_f32 v137, s81, v128
    v_sub_f32 v137, 0, v137
    v_add_f32 v138, 0x40a00000, v128
    s_branch L_back1
.section .rodata,"a"
.p2align 6
.amdhsa_kernel sequential_preLN__gqa_block_cached__mixer_token_mlp__decode_kernel
  .amdhsa_next_free_vgpr 256
  .amdhsa_next_free_sgpr 102
  .amdhsa_accum_offset 256
  .amdhsa_group_segment_fixed_size 0
  .amdhsa_kernarg_size 104
  .amdhsa_user_sgpr_count 2
  .amdhsa_user_sgpr_kernarg_segment_ptr 1
  .amdhsa_system_sgpr_workgroup_id_x 1
.end_amdhsa_kernel
```
